```python
import torch

def _softmax(x, axis=-1):
    return torch.softmax(x, dim=axis)

def _gelu(x):
    return torch.nn.functional.gelu(x, approximate='tanh')

def _silu(x):
    return torch.nn.functional.silu(x)

def _sigmoid(x):
    return torch.sigmoid(x)

def _layernorm(x, axis=-1, eps=1e-05):
    m = x.mean(dim=axis, keepdim=True)
    v = x.var(dim=axis, keepdim=True, unbiased=False)
    return (x - m) / torch.sqrt(v + eps)

def _scatter_add(tgt, idx, src, axis=0):
    return tgt.clone().index_add_(axis, idx, src)

def _segment_sum(src, seg, n):
    out = torch.zeros((n,) + src.shape[1:], dtype=src.dtype)
    return out.index_add_(0, seg, src)

def _pad(x, pw):
    flat = tuple((v for pair in reversed(pw) for v in pair))
    return torch.nn.functional.pad(x, flat)
kernel_name = 'adaLN_cond__gqa_block_cached__glu_gated_bilinear__decode'

def setup_inputs():

    _w = lambda a: (lambda t: t.to(torch.bfloat16) if t.is_floating_point() else t)(torch.as_tensor(a))

    def _A_setup():
        B, Sq, D = (1, 1, 640)
        Hq, Hkv, Sk, Dh = (32, 32, 4096, 192)
        assert Hq % Hkv == 0, (Hq, Hkv)
        return {'x': _w((lambda *s: torch.randn(*s, dtype=torch.bfloat16) * 0.1)(B, Sq, D)), 'k_cache': _w((lambda *s: torch.randn(*s, dtype=torch.bfloat16) * 0.8)(B, Hkv, Sk, Dh)), 'v_cache': _w((lambda *s: torch.randn(*s, dtype=torch.bfloat16) * 3.2)(B, Hkv, Sk, Dh)), 'wq': _w((lambda *s: torch.randn(*s, dtype=torch.bfloat16) * 0.8)(D, Hq * Dh) * D ** (-0.5)), 'wo': _w((lambda *s: torch.randn(*s, dtype=torch.bfloat16) * 3.2)(Hq * Dh, D) * (Hq * Dh) ** (-0.5))}
    _A_in = _A_setup()

    def _B_setup():
        B, S, D, F = (1, 1, 640, 1536)
        return {'x': _w((lambda *s: torch.randn(*s, dtype=torch.bfloat16) * 0.1)(B, S, D)), 'w_gate': _w((lambda *s: torch.randn(*s, dtype=torch.bfloat16) * 3.2)(D, F) * D ** (-0.5)), 'w_up': _w((lambda *s: torch.randn(*s, dtype=torch.bfloat16) * 3.2)(D, F) * D ** (-0.5)), 'w_down': _w((lambda *s: torch.randn(*s, dtype=torch.bfloat16) * 3.2)(F, D) * F ** (-0.5))}
    _B_in = _B_setup()
    return {'A_x': _A_in['x'], 'A_k_cache': _A_in['k_cache'], 'A_v_cache': _A_in['v_cache'], 'A_wq': _A_in['wq'], 'A_wo': _A_in['wo'], 'B_x': _B_in['x'], 'B_w_gate': _B_in['w_gate'], 'B_w_up': _B_in['w_up'], 'B_w_down': _B_in['w_down'], 'c': _w((lambda *s: torch.randn(*s, dtype=torch.bfloat16) * 0.4)(1, 640) * 8.0), 'w_mod': _w((lambda *s: torch.randn(*s, dtype=torch.bfloat16) * 0.4)(640, 6 * 640) * 640 ** (-0.5) * 8.0)}

def reference(A_x, A_k_cache, A_v_cache, A_wq, A_wo, B_x, B_w_gate, B_w_up, B_w_down, c, w_mod):

    def _A_ref(x, k_cache, v_cache, wq, wo):
        B, Sq, D = x.shape
        Hq, Dh = (32, 192)
        Hkv = k_cache.shape[1]
        rep = Hq // Hkv
        q = (lambda x, *d: x.permute(*d))((x @ wq).reshape(B, Sq, Hq, Dh), 0, 2, 1, 3)
        k = (lambda x, n, axis: torch.repeat_interleave(x, n, dim=axis))(k_cache, rep, axis=1)
        v = (lambda x, n, axis: torch.repeat_interleave(x, n, dim=axis))(v_cache, rep, axis=1)
        scores = torch.einsum('bhqd,bhkd->bhqk', q, k) * Dh ** (-0.5)
        p = _softmax(scores, axis=-1)
        o = torch.einsum('bhqk,bhkd->bhqd', p, v)
        return (lambda x, *d: x.permute(*d))(o, 0, 2, 1, 3).reshape(B, Sq, Hq * Dh) @ wo

    def _B_ref(x, w_gate, w_up, w_down):
        g = torch.einsum('bsd,df->bsf', x, w_gate)
        u = torch.einsum('bsd,df->bsf', x, w_up)
        h = g * u
        return torch.einsum('bsf,fd->bsd', h, w_down)
    x = A_x
    mod = (_silu(c) @ w_mod).reshape(c.shape[0], 6, 1, -1)
    sa, ca, ga, sb, cb, gb = (mod[:, 0].clone(), mod[:, 1].clone(), mod[:, 2].clone(), mod[:, 3].clone(), mod[:, 4].clone(), mod[:, 5].clone())
    h = _layernorm(x, axis=-1) * (1 + ca) + sa
    x = x + ga * _A_ref(h, A_k_cache, A_v_cache, A_wq, A_wo)
    h = _layernorm(x, axis=-1) * (1 + cb) + sb
    x = x + gb * _B_ref(h, B_w_gate, B_w_up, B_w_down)
    return x
```

```asm
; @launch grid=(256,1,1) block=(1024,1,1) lds=159744
.amdgcn_target "amdgcn-amd-amdhsa--gfx950"
.text
.globl adaLN_cond__gqa_block_cached__glu_gated_bilinear__decode_kernel
.p2align 8
.type adaLN_cond__gqa_block_cached__glu_gated_bilinear__decode_kernel,@function
adaLN_cond__gqa_block_cached__glu_gated_bilinear__decode_kernel:
s_load_dwordx2 s[8:9], s[0:1], 8
s_load_dwordx2 s[40:41], s[0:1], 80
s_load_dwordx2 s[16:17], s[0:1], 24
s_load_dwordx2 s[52:53], s[0:1], 104
s_load_dwordx2 s[36:37], s[0:1], 72
s_load_dwordx2 s[4:5], s[0:1], 0
s_load_dwordx2 s[12:13], s[0:1], 16
s_load_dwordx2 s[48:49], s[0:1], 96
s_load_dwordx2 s[20:21], s[0:1], 32
s_load_dwordx2 s[24:25], s[0:1], 48
s_load_dwordx2 s[28:29], s[0:1], 56
s_load_dwordx2 s[32:33], s[0:1], 64
s_load_dwordx2 s[44:45], s[0:1], 88
v_lshrrev_b32 v1, 6, v0
v_and_b32 v0, 63, v0
v_readfirstlane_b32 s56, v1
s_mov_b32 s6, 1280
s_mov_b32 s7, 0x20000
s_mov_b32 s10, 50331648
s_mov_b32 s11, 0x20000
s_mov_b32 s14, 50331648
s_mov_b32 s15, 0x20000
s_mov_b32 s18, 7864320
s_mov_b32 s19, 0x20000
s_mov_b32 s22, 7864320
s_mov_b32 s23, 0x20000
s_mov_b32 s26, 1966080
s_mov_b32 s27, 0x20000
s_mov_b32 s30, 1966080
s_mov_b32 s31, 0x20000
s_mov_b32 s34, 1966080
s_mov_b32 s35, 0x20000
s_mov_b32 s38, 1280
s_mov_b32 s39, 0x20000
s_mov_b32 s42, 4915200
s_mov_b32 s43, 0x20000
s_mov_b32 s46, 1280
s_mov_b32 s47, 0x20000
s_mov_b32 s50, 256
s_mov_b32 s51, 0x20000
s_mov_b32 s54, 268435456
s_mov_b32 s55, 0x20000
s_mov_b32 s3, -1
s_mov_b32 s79, 0
s_cmp_ge_u32 s2, 256
s_cbranch_scc1 L_END
s_and_b32 s57, s2, 7
s_lshr_b32 s58, s2, 3
s_lshr_b32 s59, s58, 3
s_lshl_b32 s62, s57, 2
s_add_u32 s59, s59, s62
s_and_b32 s60, s58, 7
s_and_b32 s61, s56, 7
v_lshrrev_b32 v1, 3, v0
v_mul_u32_u24 v1, 1536, v1
v_and_b32 v2, 7, v0
v_lshl_add_u32 v2, v2, 4, v1
v_mov_b32 v3, 0
v_mov_b32 v4, 1
s_lshl_b32 s67, s59, 12
s_lshl_b32 s62, s60, 9
s_add_u32 s67, s67, s62
s_mul_i32 s67, s67, 384
s_mul_i32 s65, s61, 24576
s_add_u32 s65, s65, s67
s_add_u32 s66, s65, 12288
s_lshl_b32 s62, s61, 2
v_mov_b32 v5, s62
s_waitcnt lgkmcnt(0)
s_cmp_ge_u32 s56, 8
s_cbranch_scc1 L_KWAVE
s_cmp_eq_u32 s61, 2
s_cbranch_scc1 L_F2
s_cmp_ge_u32 s61, 3
s_cbranch_scc1 L_F3
s_mul_i32 s68, s58, 43
s_lshr_b32 s68, s68, 8
s_mul_i32 s62, s68, 6
s_sub_u32 s69, s58, s62
s_lshl_b32 s71, s61, 14
s_add_u32 s71, s71, 45056
v_lshlrev_b32 v7, 2, v0
buffer_load_dword v10, v7, s[4:7], 0 offen offset:0
buffer_load_dword v11, v7, s[4:7], 0 offen offset:256
buffer_load_dword v12, v7, s[4:7], 0 offen offset:512
buffer_load_dword v13, v7, s[4:7], 0 offen offset:768
buffer_load_dword v14, v7, s[4:7], 0 offen offset:1024
v_and_b32 v8, 31, v0
v_lshlrev_b32 v8, 3, v8
s_lshl_b32 s62, s68, 8
buffer_load_dwordx2 v[16:17], v8, s[4:7], s62 offen
s_barrier
s_cmp_ge_u32 s58, 30
s_cbranch_scc1 L_F01_NODMA
v_lshrrev_b32 v7, 3, v0
v_and_b32 v8, 7, v0
v_bfe_u32 v6, v7, 1, 2
v_lshlrev_b32 v6, 1, v6
v_xor_b32 v8, v8, v6
v_mul_u32_u24 v7, 12288, v7
v_lshl_add_u32 v6, v8, 4, v7
s_mul_i32 s70, s68, 1572864
s_mul_i32 s62, s57, 1536
s_add_u32 s70, s70, s62
s_lshl_b32 s62, s69, 8
s_add_u32 s70, s70, s62
s_lshl_b32 s62, s61, 7
s_add_u32 s70, s70, s62
s_mov_b32 s63, 0
s_cbranch_execz LWD_2
LW_1:
ds_read_b32 v9, v3 offset:44
s_waitcnt lgkmcnt(0)
v_readfirstlane_b32 s62, v9
s_nop 0
s_cmp_lg_u32 s62, 0
s_cbranch_scc1 LWD_2
s_sleep 1
s_add_u32 s63, s63, 1
s_cmp_lt_u32 s63, 2400000
s_cbranch_scc1 LW_1
LWD_2:
s_cbranch_execz DS_3
s_add_u32 m0, s71, 0
s_nop 0
buffer_load_dwordx4 v6, s[16:19], s70 offen nt lds
s_add_u32 s70, s70, 98304
s_add_u32 m0, s71, 1024
s_nop 0
buffer_load_dwordx4 v6, s[16:19], s70 offen nt lds
s_add_u32 s70, s70, 98304
s_add_u32 m0, s71, 2048
s_nop 0
buffer_load_dwordx4 v6, s[16:19], s70 offen nt lds
s_add_u32 s70, s70, 98304
s_add_u32 m0, s71, 3072
s_nop 0
buffer_load_dwordx4 v6, s[16:19], s70 offen nt lds
s_add_u32 s70, s70, 98304
s_add_u32 m0, s71, 4096
s_nop 0
buffer_load_dwordx4 v6, s[16:19], s70 offen nt lds
s_add_u32 s70, s70, 98304
s_add_u32 m0, s71, 5120
s_nop 0
buffer_load_dwordx4 v6, s[16:19], s70 offen nt lds
s_add_u32 s70, s70, 98304
s_add_u32 m0, s71, 6144
s_nop 0
buffer_load_dwordx4 v6, s[16:19], s70 offen nt lds
s_add_u32 s70, s70, 98304
s_add_u32 m0, s71, 7168
s_nop 0
buffer_load_dwordx4 v6, s[16:19], s70 offen nt lds
s_add_u32 s70, s70, 98304
s_add_u32 m0, s71, 8192
s_nop 0
buffer_load_dwordx4 v6, s[16:19], s70 offen nt lds
s_add_u32 s70, s70, 98304
s_add_u32 m0, s71, 9216
s_nop 0
buffer_load_dwordx4 v6, s[16:19], s70 offen nt lds
s_add_u32 s70, s70, 98304
s_add_u32 m0, s71, 10240
s_nop 0
buffer_load_dwordx4 v6, s[16:19], s70 offen nt lds
s_add_u32 s70, s70, 98304
s_add_u32 m0, s71, 11264
s_nop 0
buffer_load_dwordx4 v6, s[16:19], s70 offen nt lds
s_add_u32 s70, s70, 98304
s_add_u32 m0, s71, 12288
s_nop 0
buffer_load_dwordx4 v6, s[16:19], s70 offen nt lds
s_add_u32 s70, s70, 98304
s_add_u32 m0, s71, 13312
s_nop 0
buffer_load_dwordx4 v6, s[16:19], s70 offen nt lds
s_add_u32 s70, s70, 98304
s_add_u32 m0, s71, 14336
s_nop 0
buffer_load_dwordx4 v6, s[16:19], s70 offen nt lds
s_add_u32 s70, s70, 98304
s_add_u32 m0, s71, 15360
s_nop 0
buffer_load_dwordx4 v6, s[16:19], s70 offen nt lds
DS_3:
s_waitcnt vmcnt(8)
L_F01_NODMA:
s_and_b32 exec_lo, s3, 1
s_mov_b32 exec_hi, 0
ds_add_u32 v3, v4 offset:48
s_mov_b32 exec_lo, s3
s_mov_b32 exec_hi, s3
L_F01_DRY:
s_waitcnt vmcnt(0)
s_cmp_ge_u32 s58, 30
s_cbranch_scc1 L_F01_SKIPB
v_lshrrev_b32 v44, 2, v0
v_mul_u32_u24 v44, 128, v44
v_and_b32 v45, 3, v0
v_lshl_add_u32 v44, v45, 3, v44
v_add_u32 v44, s71, v44
v_bfe_u32 v45, v0, 3, 2
v_xor_b32 v40, 0, v45
v_lshl_add_u32 v40, v40, 5, v44
v_xor_b32 v41, 1, v45
v_lshl_add_u32 v41, v41, 5, v44
v_xor_b32 v42, 2, v45
v_lshl_add_u32 v42, v42, 5, v44
v_xor_b32 v43, 3, v45
v_lshl_add_u32 v43, v43, 5, v44
ds_read_b64_tr_b16 v[64:65], v40 offset:0
ds_read_b64_tr_b16 v[66:67], v40 offset:2048
ds_read_b64_tr_b16 v[68:69], v41 offset:0
ds_read_b64_tr_b16 v[70:71], v41 offset:2048
ds_read_b64_tr_b16 v[72:73], v42 offset:0
ds_read_b64_tr_b16 v[74:75], v42 offset:2048
ds_read_b64_tr_b16 v[76:77], v43 offset:0
ds_read_b64_tr_b16 v[78:79], v43 offset:2048
ds_read_b64_tr_b16 v[80:81], v40 offset:4096
ds_read_b64_tr_b16 v[82:83], v40 offset:6144
ds_read_b64_tr_b16 v[84:85], v41 offset:4096
ds_read_b64_tr_b16 v[86:87], v41 offset:6144
ds_read_b64_tr_b16 v[88:89], v42 offset:4096
ds_read_b64_tr_b16 v[90:91], v42 offset:6144
ds_read_b64_tr_b16 v[92:93], v43 offset:4096
ds_read_b64_tr_b16 v[94:95], v43 offset:6144
ds_read_b64_tr_b16 v[96:97], v40 offset:8192
ds_read_b64_tr_b16 v[98:99], v40 offset:10240
ds_read_b64_tr_b16 v[100:101], v41 offset:8192
ds_read_b64_tr_b16 v[102:103], v41 offset:10240
ds_read_b64_tr_b16 v[104:105], v42 offset:8192
ds_read_b64_tr_b16 v[106:107], v42 offset:10240
ds_read_b64_tr_b16 v[108:109], v43 offset:8192
ds_read_b64_tr_b16 v[110:111], v43 offset:10240
ds_read_b64_tr_b16 v[112:113], v40 offset:12288
ds_read_b64_tr_b16 v[114:115], v40 offset:14336
ds_read_b64_tr_b16 v[116:117], v41 offset:12288
ds_read_b64_tr_b16 v[118:119], v41 offset:14336
ds_read_b64_tr_b16 v[120:121], v42 offset:12288
ds_read_b64_tr_b16 v[122:123], v42 offset:14336
ds_read_b64_tr_b16 v[124:125], v43 offset:12288
ds_read_b64_tr_b16 v[126:127], v43 offset:14336
v_lshrrev_b32 v46, 4, v0
v_lshlrev_b32 v46, 3, v46
s_waitcnt lgkmcnt(0)
s_and_b32 exec_lo, s3, 1
s_mov_b32 exec_hi, 0
ds_add_u32 v3, v4 offset:28
s_mov_b32 exec_lo, s3
s_mov_b32 exec_hi, s3
s_cmp_eq_u32 s61, 1
s_cbranch_scc1 L_F1_WAITH
v_mov_b32 v29, 0x3acccccd
s_mov_b32 s62, 1065369472
v_dot2_f32_bf16 v30, v10, s62, 0
v_dot2_f32_bf16 v31, v10, v10, 0
v_dot2_f32_bf16 v30, v11, s62, v30
v_dot2_f32_bf16 v31, v11, v11, v31
v_dot2_f32_bf16 v30, v12, s62, v30
v_dot2_f32_bf16 v31, v12, v12, v31
v_dot2_f32_bf16 v30, v13, s62, v30
v_dot2_f32_bf16 v31, v13, v13, v31
v_dot2_f32_bf16 v30, v14, s62, v30
v_dot2_f32_bf16 v31, v14, v14, v31
s_nop 1
v_add_f32_dpp v30, v30, v30 quad_perm:[1,0,3,2] row_mask:0xf bank_mask:0xf
v_add_f32_dpp v31, v31, v31 quad_perm:[1,0,3,2] row_mask:0xf bank_mask:0xf
s_nop 0
v_add_f32_dpp v30, v30, v30 quad_perm:[2,3,0,1] row_mask:0xf bank_mask:0xf
v_add_f32_dpp v31, v31, v31 quad_perm:[2,3,0,1] row_mask:0xf bank_mask:0xf
s_nop 0
v_add_f32_dpp v30, v30, v30 row_half_mirror row_mask:0xf bank_mask:0xf
v_add_f32_dpp v31, v31, v31 row_half_mirror row_mask:0xf bank_mask:0xf
s_nop 0
v_add_f32_dpp v30, v30, v30 row_mirror row_mask:0xf bank_mask:0xf
v_add_f32_dpp v31, v31, v31 row_mirror row_mask:0xf bank_mask:0xf
s_nop 0
v_add_f32_dpp v30, v30, v30 row_bcast:15 row_mask:0xa bank_mask:0xf
v_add_f32_dpp v31, v31, v31 row_bcast:15 row_mask:0xa bank_mask:0xf
s_nop 0
v_add_f32_dpp v30, v30, v30 row_bcast:31 row_mask:0xc bank_mask:0xf
v_add_f32_dpp v31, v31, v31 row_bcast:31 row_mask:0xc bank_mask:0xf
v_readlane_b32 s62, v30, 63
v_readlane_b32 s63, v31, 63
s_nop 0
v_mul_f32 v30, s62, v29
v_mul_f32 v31, s63, v29
v_fma_f32 v31, -v30, v30, v31
v_max_f32 v31, 0, v31
v_cvt_pk_bf16_f32 v33, v30, v31
v_lshlrev_b32 v30, 16, v33
v_and_b32 v31, 0xffff0000, v33
v_add_f32 v31, 0x3727c5ac, v31
v_cvt_pk_bf16_f32 v31, v31, v31
v_and_b32 v31, 0xffff0000, v31
v_sqrt_f32 v31, v31
s_nop 0
v_cvt_pk_bf16_f32 v31, v31, v31
v_and_b32 v31, 0xffff0000, v31
v_rcp_f32 v32, v31
v_lshlrev_b32 v34, 16, v16
v_and_b32 v35, 0xffff0000, v16
v_lshlrev_b32 v36, 16, v17
v_and_b32 v37, 0xffff0000, v17
v_pk_add_f32 v[34:35], v[34:35], v[30:31] op_sel_hi:[1,0] neg_lo:[0,1] neg_hi:[0,1]
v_pk_add_f32 v[36:37], v[36:37], v[30:31] op_sel_hi:[1,0] neg_lo:[0,1] neg_hi:[0,1]
v_cvt_pk_bf16_f32 v35, v34, v35
v_cvt_pk_bf16_f32 v37, v36, v37
v_lshlrev_b32 v34, 16, v35
v_and_b32 v35, 0xffff0000, v35
v_lshlrev_b32 v36, 16, v37
v_and_b32 v37, 0xffff0000, v37
v_pk_mul_f32 v[34:35], v[34:35], v[32:33] op_sel_hi:[1,0]
v_pk_mul_f32 v[36:37], v[36:37], v[32:33] op_sel_hi:[1,0]
v_cvt_pk_bf16_f32 v35, v34, v35
v_cvt_pk_bf16_f32 v37, v36, v37
v_lshlrev_b32 v34, 16, v35
v_and_b32 v35, 0xffff0000, v35
v_lshlrev_b32 v36, 16, v37
v_and_b32 v37, 0xffff0000, v37
v_and_b32 v8, 31, v0
v_lshlrev_b32 v8, 2, v8
v_lshrrev_b32 v9, 5, v0
v_mul_u32_u24 v9, 640, v9
v_add_u32 v8, v8, v9
s_lshl_b32 s62, s68, 7
v_add_u32 v8, s62, v8
v_lshrrev_b32 v9, 6, v8
v_lshlrev_b32 v9, 11, v9
v_and_b32 v8, 63, v8
v_lshl_add_u32 v8, v8, 2, v9
s_mov_b32 s63, 0
s_cbranch_execz LWD_5
LW_4:
ds_read_b32 v9, v3 offset:0
s_waitcnt lgkmcnt(0)
v_readfirstlane_b32 s62, v9
s_nop 0
s_cmp_lg_u32 s62, 0
s_cbranch_scc1 LWD_5
s_sleep 1
s_add_u32 s63, s63, 1
s_cmp_lt_u32 s63, 2400000
s_cbranch_scc1 LW_4
LWD_5:
s_mov_b32 s79, s62
s_mov_b32 s64, 917504
v_and_b32 v47, 31, v0
v_lshlrev_b32 v47, 3, v47
s_lshl_b32 s72, s57, 8
s_add_u32 s72, s72, 98304
s_mov_b32 s63, 0
PL_6:
buffer_load_dwordx4 v[10:13], v8, s[52:55], s64 offen offset:0 sc1
buffer_load_dwordx4 v[14:17], v8, s[52:55], s64 offen offset:256 sc1
buffer_load_dwordx4 v[18:21], v8, s[52:55], s64 offen offset:512 sc1
buffer_load_dwordx4 v[22:25], v8, s[52:55], s64 offen offset:768 sc1
buffer_load_dwordx4 v[48:51], v8, s[52:55], s64 offen offset:1024 sc1
buffer_load_dwordx4 v[52:55], v8, s[52:55], s64 offen offset:1280 sc1
buffer_load_dwordx4 v[56:59], v8, s[52:55], s64 offen offset:1536 sc1
buffer_load_dwordx4 v[60:63], v8, s[52:55], s64 offen offset:1792 sc1
buffer_load_dwordx2 v[38:39], v47, s[52:55], s72 offen sc1
s_waitcnt vmcnt(0)
v_xor_b32 v9, s79, v11
v_xor_b32 v15, s79, v15
v_xor_b32 v19, s79, v19
v_xor_b32 v23, s79, v23
v_xor_b32 v49, s79, v49
v_xor_b32 v53, s79, v53
v_xor_b32 v57, s79, v57
v_xor_b32 v61, s79, v61
v_xor_b32 v13, s79, v13
v_xor_b32 v17, s79, v17
v_xor_b32 v21, s79, v21
v_xor_b32 v25, s79, v25
v_xor_b32 v51, s79, v51
v_xor_b32 v55, s79, v55
v_xor_b32 v59, s79, v59
v_xor_b32 v63, s79, v63
v_xor_b32 v38, s79, v38
v_or3_b32 v9, v9, v15, v19
v_or3_b32 v9, v9, v23, v49
v_or3_b32 v9, v9, v53, v57
v_or3_b32 v9, v9, v61, v13
v_or3_b32 v9, v9, v17, v21
v_or3_b32 v9, v9, v25, v51
v_or3_b32 v9, v9, v55, v59
v_or3_b32 v9, v9, v63, v38
v_cmp_ne_u32 vcc, 0, v9
s_cbranch_vccz PD_7
s_sleep 1
s_add_u32 s63, s63, 1
s_cmp_lt_u32 s63, 300000
s_cbranch_scc1 PL_6
PD_7:
s_getreg_b32 s62, hwreg(HW_REG_XCC_ID)
s_and_b32 s62, s62, 15
s_add_u32 s62, s62, 1
v_cmp_ne_u32 vcc, s62, v39
s_nop 0
s_cmp_eq_u64 vcc, 0
s_cselect_b32 s62, 1, 2
v_mov_b32 v9, s62
ds_write_b32 v3, v9 offset:60
v_add_f32 v10, v10, v18
v_add_f32 v48, v48, v56
v_add_f32 v26, v10, v48
v_add_f32 v12, v12, v20
v_add_f32 v50, v50, v58
v_add_f32 v27, v12, v50
v_add_f32 v14, v14, v22
v_add_f32 v52, v52, v60
v_add_f32 v28, v14, v52
v_add_f32 v16, v16, v24
v_add_f32 v54, v54, v62
v_add_f32 v29, v16, v54
v_cvt_pk_bf16_f32 v49, v26, v27
v_cvt_pk_bf16_f32 v51, v28, v29
v_lshlrev_b32 v48, 16, v49
v_and_b32 v49, 0xffff0000, v49
v_lshlrev_b32 v50, 16, v51
v_and_b32 v51, 0xffff0000, v51
v_mov_b32 v52, v48
v_mov_b32 v53, v49
v_mov_b32 v54, v50
v_mov_b32 v55, v51
v_permlane32_swap_b32 v48, v52
v_permlane32_swap_b32 v49, v53
v_permlane32_swap_b32 v50, v54
v_permlane32_swap_b32 v51, v55
v_add_f32 v52, 1.0, v52
v_add_f32 v53, 1.0, v53
v_add_f32 v54, 1.0, v54
v_add_f32 v55, 1.0, v55
v_cvt_pk_bf16_f32 v53, v52, v53
v_cvt_pk_bf16_f32 v55, v54, v55
v_lshlrev_b32 v52, 16, v53
v_and_b32 v53, 0xffff0000, v53
v_lshlrev_b32 v54, 16, v55
v_and_b32 v55, 0xffff0000, v55
v_mul_f32 v52, v34, v52
v_mul_f32 v53, v35, v53
v_mul_f32 v54, v36, v54
v_mul_f32 v55, v37, v55
v_cvt_pk_bf16_f32 v53, v52, v53
v_cvt_pk_bf16_f32 v55, v54, v55
v_lshlrev_b32 v52, 16, v53
v_and_b32 v53, 0xffff0000, v53
v_lshlrev_b32 v54, 16, v55
v_and_b32 v55, 0xffff0000, v55
v_add_f32 v52, v52, v48
v_add_f32 v53, v53, v49
v_add_f32 v54, v54, v50
v_add_f32 v55, v55, v51
v_cvt_pk_bf16_f32 v56, v52, v53
v_cvt_pk_bf16_f32 v57, v54, v55
v_and_b32 v8, 31, v0
v_lshlrev_b32 v8, 3, v8
ds_write_b64 v8, v[56:57] offset:640
ds_write_b32 v3, v4 offset:4
s_branch L_F01_C
L_F1_WAITH:
s_mov_b32 s63, 0
s_cbranch_execz LWD_9
LW_8:
ds_read_b32 v18, v3 offset:4
s_waitcnt lgkmcnt(0)
v_readfirstlane_b32 s62, v18
s_nop 0
s_cmp_lg_u32 s62, 0
s_cbranch_scc1 LWD_9
s_sleep 1
s_add_u32 s63, s63, 1
s_cmp_lt_u32 s63, 2400000
s_cbranch_scc1 LW_8
LWD_9:
L_F01_C:
ds_read2_b64 v[48:51], v46 offset0:80 offset1:84
ds_read2_b64 v[52:55], v46 offset0:88 offset1:92
ds_read2_b64 v[56:59], v46 offset0:96 offset1:100
ds_read2_b64 v[60:63], v46 offset0:104 offset1:108
v_mov_b32 v20, 0
v_mov_b32 v21, 0
v_mov_b32 v22, 0
v_mov_b32 v23, 0
v_mov_b32 v24, 0
v_mov_b32 v25, 0
v_mov_b32 v26, 0
v_mov_b32 v27, 0
v_mov_b32 v28, 0
v_mov_b32 v29, 0
v_mov_b32 v30, 0
v_mov_b32 v31, 0
v_mov_b32 v32, 0
v_mov_b32 v33, 0
v_mov_b32 v34, 0
v_mov_b32 v35, 0
v_and_b32 v8, 15, v0
v_lshlrev_b32 v8, 6, v8
v_lshrrev_b32 v9, 4, v0
v_lshl_add_u32 v8, v9, 4, v8
s_mul_i32 s70, s68, 24576
s_mul_i32 s62, s57, 3072
s_add_u32 s70, s70, s62
s_lshl_b32 s62, s69, 9
s_add_u32 s70, s70, s62
s_lshl_b32 s62, s61, 8
s_add_u32 s70, s70, s62
s_add_u32 s72, s70, 131072
s_waitcnt lgkmcnt(0)
v_mfma_f32_16x16x32_bf16 v[20:23], v[64:67], v[48:51], v[20:23]
v_mfma_f32_16x16x32_bf16 v[24:27], v[68:71], v[48:51], v[24:27]
v_mfma_f32_16x16x32_bf16 v[28:31], v[72:75], v[48:51], v[28:31]
v_mfma_f32_16x16x32_bf16 v[32:35], v[76:79], v[48:51], v[32:35]
v_mfma_f32_16x16x32_bf16 v[20:23], v[80:83], v[52:55], v[20:23]
v_mfma_f32_16x16x32_bf16 v[24:27], v[84:87], v[52:55], v[24:27]
v_mfma_f32_16x16x32_bf16 v[28:31], v[88:91], v[52:55], v[28:31]
v_mfma_f32_16x16x32_bf16 v[32:35], v[92:95], v[52:55], v[32:35]
v_mfma_f32_16x16x32_bf16 v[20:23], v[96:99], v[56:59], v[20:23]
v_mfma_f32_16x16x32_bf16 v[24:27], v[100:103], v[56:59], v[24:27]
v_mfma_f32_16x16x32_bf16 v[28:31], v[104:107], v[56:59], v[28:31]
v_mfma_f32_16x16x32_bf16 v[32:35], v[108:111], v[56:59], v[32:35]
v_mfma_f32_16x16x32_bf16 v[20:23], v[112:115], v[60:63], v[20:23]
v_mfma_f32_16x16x32_bf16 v[24:27], v[116:119], v[60:63], v[24:27]
v_mfma_f32_16x16x32_bf16 v[28:31], v[120:123], v[60:63], v[28:31]
v_mfma_f32_16x16x32_bf16 v[32:35], v[124:127], v[60:63], v[32:35]
s_mov_b32 s63, 0
s_cbranch_execz LWD_11
LW_10:
ds_read_b32 v9, v3 offset:16
s_waitcnt lgkmcnt(0)
v_readfirstlane_b32 s62, v9
s_nop 0
s_cmp_lg_u32 s62, 0
s_cbranch_scc1 LWD_11
s_sleep 1
s_add_u32 s63, s63, 1
s_cmp_lt_u32 s63, 2400000
s_cbranch_scc1 LW_10
LWD_11:
s_mov_b32 s63, 0
s_cbranch_execz LWD_13
LW_12:
ds_read_b32 v9, v3 offset:60
s_waitcnt lgkmcnt(0)
v_readfirstlane_b32 s62, v9
s_nop 0
s_cmp_lg_u32 s62, 0
s_cbranch_scc1 LWD_13
s_sleep 1
s_add_u32 s63, s63, 1
s_cmp_lt_u32 s63, 2400000
s_cbranch_scc1 LW_12
LWD_13:
s_mov_b32 s73, s62
v_mov_b32 v36, v20
v_mov_b32 v37, v21
v_mov_b32 v38, v22
v_mov_b32 v39, v23
s_mov_b32 s80, 131074
s_mov_b32 s81, 131074
v_cndmask_b32 v36, v36, v24, s[80:81]
v_cndmask_b32 v37, v37, v25, s[80:81]
v_cndmask_b32 v38, v38, v26, s[80:81]
v_cndmask_b32 v39, v39, v27, s[80:81]
s_mov_b32 s80, 262148
s_mov_b32 s81, 262148
v_cndmask_b32 v36, v36, v28, s[80:81]
v_cndmask_b32 v37, v37, v29, s[80:81]
v_cndmask_b32 v38, v38, v30, s[80:81]
v_cndmask_b32 v39, v39, v31, s[80:81]
s_mov_b32 s80, 524296
s_mov_b32 s81, 524296
v_cndmask_b32 v36, v36, v32, s[80:81]
v_cndmask_b32 v37, v37, v33, s[80:81]
v_cndmask_b32 v38, v38, v34, s[80:81]
v_cndmask_b32 v39, v39, v35, s[80:81]
v_or_b32 v36, 1, v36
v_or_b32 v37, 1, v37
v_or_b32 v38, 1, v38
v_or_b32 v39, 1, v39
s_and_b32 exec_lo, s3, 983055
s_and_b32 exec_hi, s3, 983055
s_cmp_eq_u32 s73, 1
s_cbranch_scc1 LS_14
buffer_store_dwordx4 v[36:39], v8, s[52:55], s72 offen sc1
s_branch LSE_15
LS_14:
buffer_store_dwordx4 v[36:39], v8, s[52:55], s72 offen
LSE_15:
s_mov_b32 exec_lo, s3
s_mov_b32 exec_hi, s3
s_branch L_F01_D
L_F01_SKIPB:
s_and_b32 exec_lo, s3, 1
s_mov_b32 exec_hi, 0
ds_add_u32 v3, v4 offset:28
s_mov_b32 exec_lo, s3
s_mov_b32 exec_hi, s3
s_mov_b32 s63, 0
s_cbranch_execz LWD_17
LW_16:
ds_read_b32 v9, v3 offset:0
s_waitcnt lgkmcnt(0)
v_readfirstlane_b32 s62, v9
s_nop 0
s_cmp_lg_u32 s62, 0
s_cbranch_scc1 LWD_17
s_sleep 1
s_add_u32 s63, s63, 1
s_cmp_lt_u32 s63, 2400000
s_cbranch_scc1 LW_16
LWD_17:
s_mov_b32 s79, s62
s_mov_b32 s63, 0
s_cbranch_execz LWD_19
LW_18:
ds_read_b32 v9, v3 offset:16
s_waitcnt lgkmcnt(0)
v_readfirstlane_b32 s62, v9
s_nop 0
s_cmp_lg_u32 s62, 0
s_cbranch_scc1 LWD_19
s_sleep 1
s_add_u32 s63, s63, 1
s_cmp_lt_u32 s63, 2400000
s_cbranch_scc1 LW_18
LWD_19:
L_F01_D:
s_cmp_eq_u32 s61, 1
s_cbranch_scc1 L_F1_T
s_cmp_lt_u32 s58, 30
s_cbranch_scc1 L_F0_QG
v_and_b32 v8, 31, v0
v_lshlrev_b32 v8, 3, v8
s_lshl_b32 s64, s57, 8
s_add_u32 s64, s64, 98304
s_mov_b32 s63, 0
PL_20:
buffer_load_dwordx2 v[10:11], v8, s[52:55], s64 offen sc1
s_waitcnt vmcnt(0)
v_xor_b32 v9, s79, v10
v_cmp_ne_u32 vcc, 0, v9
s_cbranch_vccz PD_21
s_sleep 8
s_add_u32 s63, s63, 1
s_cmp_lt_u32 s63, 300000
s_cbranch_scc1 PL_20
PD_21:
s_getreg_b32 s62, hwreg(HW_REG_XCC_ID)
s_and_b32 s62, s62, 15
s_add_u32 s62, s62, 1
v_cmp_ne_u32 vcc, s62, v11
s_nop 0
s_cmp_eq_u64 vcc, 0
s_cselect_b32 s62, 1, 2
v_mov_b32 v9, s62
ds_write_b32 v3, v9 offset:60
L_F0_QG:
v_lshlrev_b32 v40, 4, v0
s_mul_i32 s62, s59, 768
v_add_u32 v40, s62, v40
v_add_u32 v41, 24576, v40
v_add_u32 v42, 49152, v40
v_add_u32 v43, 73728, v40
v_add_u32 v44, 98304, v40
v_lshlrev_b32 v8, 3, v0
s_mov_b32 exec_lo, s3
s_and_b32 exec_hi, s3, 65535
s_mov_b32 s63, 0
s_mov_b32 s64, 131072
PL_22:
buffer_load_dwordx4 v[48:51], v40, s[52:55], s64 offen sc1
buffer_load_dwordx4 v[52:55], v41, s[52:55], s64 offen sc1
buffer_load_dwordx4 v[56:59], v42, s[52:55], s64 offen sc1
buffer_load_dwordx4 v[60:63], v43, s[52:55], s64 offen sc1
buffer_load_dwordx4 v[64:67], v44, s[52:55], s64 offen sc1
s_waitcnt vmcnt(0)
v_min3_u32 v18, v48, v49, v50
v_min3_u32 v18, v18, v51, v52
v_min3_u32 v18, v18, v53, v54
v_min3_u32 v18, v18, v55, v56
v_min3_u32 v18, v18, v57, v58
v_min3_u32 v18, v18, v59, v60
v_min3_u32 v18, v18, v61, v62
v_min3_u32 v18, v18, v63, v64
v_min3_u32 v18, v18, v65, v66
v_min_u32 v18, v18, v67
v_cmp_eq_u32 vcc, 0, v18
s_cbranch_vccz PD_23
s_sleep 1
s_add_u32 s63, s63, 1
s_cmp_lt_u32 s63, 300000
s_cbranch_scc1 PL_22
PD_23:
v_pk_add_f32 v[48:49], v[48:49], v[52:53]
v_pk_add_f32 v[50:51], v[50:51], v[54:55]
v_pk_add_f32 v[56:57], v[56:57], v[60:61]
v_pk_add_f32 v[58:59], v[58:59], v[62:63]
v_pk_add_f32 v[48:49], v[48:49], v[56:57]
v_pk_add_f32 v[50:51], v[50:51], v[58:59]
v_pk_add_f32 v[48:49], v[48:49], v[64:65]
v_pk_add_f32 v[50:51], v[50:51], v[66:67]
v_cvt_pk_bf16_f32 v56, v48, v49
v_cvt_pk_bf16_f32 v57, v50, v51
ds_write_b64 v8, v[56:57] offset:896
s_mov_b32 exec_lo, s3
s_mov_b32 exec_hi, s3
ds_write_b32 v3, v4 offset:8
s_lshl_b32 s62, s59, 9
v_add_u32 v14, s62, v8
s_mov_b32 s63, 0
s_mov_b32 s64, 393216
PL_24:
buffer_load_dwordx2 v[12:13], v14, s[52:55], s64 offen sc1
s_waitcnt vmcnt(0)
v_min_u32 v15, v12, v13
v_cmp_eq_u32 vcc, 0, v15
s_cbranch_vccz PD_25
s_sleep 2
s_add_u32 s63, s63, 1
s_cmp_lt_u32 s63, 300000
s_cbranch_scc1 PL_24
PD_25:
v_and_b32 v12, 0xffff0000, v12
v_mov_b32 v16, v12
s_nop 1
v_max_f32_dpp v16, v16, v16 quad_perm:[1,0,3,2] row_mask:0xf bank_mask:0xf
s_nop 1
v_max_f32_dpp v16, v16, v16 quad_perm:[2,3,0,1] row_mask:0xf bank_mask:0xf
s_nop 1
v_max_f32_dpp v16, v16, v16 row_half_mirror row_mask:0xf bank_mask:0xf
s_nop 1
v_max_f32_dpp v16, v16, v16 row_mirror row_mask:0xf bank_mask:0xf
v_mov_b32 v15, v16
s_nop 1
v_permlane16_swap_b32 v16, v15
v_max_f32 v16, v16, v15
v_mov_b32 v15, v16
s_nop 1
v_permlane32_swap_b32 v16, v15
v_max_f32 v16, v16, v15
v_sub_f32 v12, v12, v16
v_mul_f32 v12, 1069066811, v12
v_exp_f32 v12, v12
s_nop 0
v_mul_f32 v17, v12, v13
s_nop 1
v_add_f32_dpp v17, v17, v17 quad_perm:[1,0,3,2] row_mask:0xf bank_mask:0xf
s_nop 1
v_add_f32_dpp v17, v17, v17 quad_perm:[2,3,0,1] row_mask:0xf bank_mask:0xf
s_nop 1
v_add_f32_dpp v17, v17, v17 row_half_mirror row_mask:0xf bank_mask:0xf
s_nop 1
v_add_f32_dpp v17, v17, v17 row_mirror row_mask:0xf bank_mask:0xf
v_mov_b32 v15, v17
s_nop 1
v_permlane16_swap_b32 v17, v15
v_add_f32 v17, v17, v15
v_mov_b32 v15, v17
s_nop 1
v_permlane32_swap_b32 v17, v15
v_add_f32 v17, v17, v15
ds_write_b64 v3, v[16:17] offset:192
ds_write_b32 v3, v4 offset:12
s_branch L_F01_PV
L_F1_T:
s_cmp_lt_u32 s58, 20
s_cbranch_scc1 L_F01_PV
s_cmp_lt_u32 s58, 30
s_cbranch_scc1 NR_26
s_cmp_ge_u32 s57, 4
s_cbranch_scc1 L_F01_PV
NR_26:
s_mov_b32 s63, 0
s_cbranch_execz LWD_28
LW_27:
ds_read_b32 v9, v3 offset:0
s_waitcnt lgkmcnt(0)
v_readfirstlane_b32 s62, v9
s_nop 0
s_cmp_lg_u32 s62, 0
s_cbranch_scc1 LWD_28
s_sleep 1
s_add_u32 s63, s63, 1
s_cmp_lt_u32 s63, 2400000
s_cbranch_scc1 LW_27
LWD_28:
s_mov_b32 s79, s62
v_lshlrev_b32 v8, 4, v0
s_mov_b32 s64, 106496
s_mov_b32 s72, 98304
s_mov_b32 s73, 110592
s_cmp_ge_u32 s57, 4
s_cbranch_scc1 L_F1_TD
s_mov_b32 s63, 0
PL_29:
buffer_load_dwordx4 v[12:15], v8, s[52:55], s72 offen sc1
buffer_load_dwordx4 v[48:51], v8, s[52:55], s72 offen offset:1024 sc1
buffer_load_dwordx4 v[16:19], v8, s[52:55], s64 offen offset:0 sc1
buffer_load_dwordx4 v[20:23], v8, s[52:55], s64 offen offset:1024 sc1
buffer_load_dwordx4 v[24:27], v8, s[52:55], s64 offen offset:2048 sc1
buffer_load_dwordx4 v[28:31], v8, s[52:55], s64 offen offset:3072 sc1
buffer_load_dwordx4 v[32:35], v8, s[52:55], s73 offen offset:0 sc1
buffer_load_dwordx4 v[36:39], v8, s[52:55], s73 offen offset:1024 sc1
buffer_load_dwordx4 v[40:43], v8, s[52:55], s73 offen offset:2048 sc1
buffer_load_dwordx4 v[44:47], v8, s[52:55], s73 offen offset:3072 sc1
s_waitcnt vmcnt(0)
v_xor_b32 v9, s79, v12
v_xor_b32 v14, s79, v14
v_xor_b32 v48, s79, v48
v_xor_b32 v50, s79, v50
v_xor_b32 v17, s79, v17
v_xor_b32 v21, s79, v21
v_xor_b32 v25, s79, v25
v_xor_b32 v29, s79, v29
v_xor_b32 v33, s79, v33
v_xor_b32 v37, s79, v37
v_xor_b32 v41, s79, v41
v_xor_b32 v45, s79, v45
v_xor_b32 v19, s79, v19
v_xor_b32 v23, s79, v23
v_xor_b32 v27, s79, v27
v_xor_b32 v31, s79, v31
v_xor_b32 v35, s79, v35
v_xor_b32 v39, s79, v39
v_xor_b32 v43, s79, v43
v_xor_b32 v47, s79, v47
v_or3_b32 v9, v9, v14, v48
v_or3_b32 v9, v9, v50, v17
v_or3_b32 v9, v9, v21, v25
v_or3_b32 v9, v9, v29, v33
v_or3_b32 v9, v9, v37, v41
v_or3_b32 v9, v9, v45, v19
v_or3_b32 v9, v9, v23, v27
v_or3_b32 v9, v9, v31, v35
v_or3_b32 v9, v9, v39, v43
v_or_b32 v9, v9, v47
v_cmp_ne_u32 vcc, 0, v9
s_cbranch_vccz PD_30
s_sleep 8
s_add_u32 s63, s63, 1
s_cmp_lt_u32 s63, 300000
s_cbranch_scc1 PL_29
PD_30:
v_and_b32 v19, 0xffff0000, v18
v_lshlrev_b32 v18, 16, v18
v_and_b32 v17, 0xffff0000, v16
v_lshlrev_b32 v16, 16, v16
ds_write_b128 v8, v[16:19] offset:12288
v_and_b32 v23, 0xffff0000, v22
v_lshlrev_b32 v22, 16, v22
v_and_b32 v21, 0xffff0000, v20
v_lshlrev_b32 v20, 16, v20
ds_write_b128 v8, v[20:23] offset:13312
v_and_b32 v27, 0xffff0000, v26
v_lshlrev_b32 v26, 16, v26
v_and_b32 v25, 0xffff0000, v24
v_lshlrev_b32 v24, 16, v24
ds_write_b128 v8, v[24:27] offset:14336
v_and_b32 v31, 0xffff0000, v30
v_lshlrev_b32 v30, 16, v30
v_and_b32 v29, 0xffff0000, v28
v_lshlrev_b32 v28, 16, v28
ds_write_b128 v8, v[28:31] offset:15360
v_and_b32 v35, 0xffff0000, v34
v_lshlrev_b32 v34, 16, v34
v_and_b32 v33, 0xffff0000, v32
v_lshlrev_b32 v32, 16, v32
ds_write_b128 v8, v[32:35] offset:16384
v_and_b32 v39, 0xffff0000, v38
v_lshlrev_b32 v38, 16, v38
v_and_b32 v37, 0xffff0000, v36
v_lshlrev_b32 v36, 16, v36
v_add_f32 v36, 1.0, v36
v_add_f32 v37, 1.0, v37
v_add_f32 v38, 1.0, v38
v_add_f32 v39, 1.0, v39
v_cvt_pk_bf16_f32 v37, v36, v37
v_cvt_pk_bf16_f32 v39, v38, v39
v_lshlrev_b32 v36, 16, v37
v_and_b32 v37, 0xffff0000, v37
v_lshlrev_b32 v38, 16, v39
v_and_b32 v39, 0xffff0000, v39
ds_write_b128 v8, v[36:39] offset:17408
v_and_b32 v43, 0xffff0000, v42
v_lshlrev_b32 v42, 16, v42
v_and_b32 v41, 0xffff0000, v40
v_lshlrev_b32 v40, 16, v40
v_add_f32 v40, 1.0, v40
v_add_f32 v41, 1.0, v41
v_add_f32 v42, 1.0, v42
v_add_f32 v43, 1.0, v43
v_cvt_pk_bf16_f32 v41, v40, v41
v_cvt_pk_bf16_f32 v43, v42, v43
v_lshlrev_b32 v40, 16, v41
v_and_b32 v41, 0xffff0000, v41
v_lshlrev_b32 v42, 16, v43
v_and_b32 v43, 0xffff0000, v43
ds_write_b128 v8, v[40:43] offset:18432
v_and_b32 v47, 0xffff0000, v46
v_lshlrev_b32 v46, 16, v46
v_and_b32 v45, 0xffff0000, v44
v_lshlrev_b32 v44, 16, v44
v_add_f32 v44, 1.0, v44
v_add_f32 v45, 1.0, v45
v_add_f32 v46, 1.0, v46
v_add_f32 v47, 1.0, v47
v_cvt_pk_bf16_f32 v45, v44, v45
v_cvt_pk_bf16_f32 v47, v46, v47
v_lshlrev_b32 v44, 16, v45
v_and_b32 v45, 0xffff0000, v45
v_lshlrev_b32 v46, 16, v47
v_and_b32 v47, 0xffff0000, v47
ds_write_b128 v8, v[44:47] offset:19456
ds_write_b32 v3, v4 offset:36
s_branch L_F01_PV
L_F1_TD:
s_mul_i32 s75, s57, 10
s_add_u32 s75, s75, s58
s_sub_u32 s75, s75, 60
v_and_b32 v10, 3, v0
v_lshlrev_b32 v10, 4, v10
s_lshl_b32 s62, s75, 6
s_add_u32 s64, s62, 114176
s_mov_b32 s63, 0
PL_31:
buffer_load_dwordx4 v[12:15], v8, s[52:55], s72 offen sc1
buffer_load_dwordx4 v[48:51], v8, s[52:55], s72 offen offset:1024 sc1
buffer_load_dwordx4 v[16:19], v10, s[52:55], s64 offen sc1
s_waitcnt vmcnt(0)
v_xor_b32 v9, s79, v12
v_xor_b32 v14, s79, v14
v_xor_b32 v48, s79, v48
v_xor_b32 v50, s79, v50
v_xor_b32 v17, s79, v17
v_xor_b32 v19, s79, v19
v_or3_b32 v9, v9, v14, v48
v_or3_b32 v9, v9, v50, v17
v_or_b32 v9, v9, v19
v_cmp_ne_u32 vcc, 0, v9
s_cbranch_vccz PD_32
s_sleep 8
s_add_u32 s63, s63, 1
s_cmp_lt_u32 s63, 300000
s_cbranch_scc1 PL_31
PD_32:
v_and_b32 v19, 0xffff0000, v18
v_lshlrev_b32 v18, 16, v18
v_and_b32 v17, 0xffff0000, v16
v_lshlrev_b32 v16, 16, v16
ds_write_b128 v10, v[16:19] offset:12288
ds_write_b32 v3, v4 offset:36
L_F01_PV:
s_cbranch_execz L_DRYRET
s_mov_b32 s63, 0
s_cbranch_execz LWD_34
LW_33:
ds_read_b32 v9, v3 offset:32
s_waitcnt lgkmcnt(0)
v_readfirstlane_b32 s62, v9
s_nop 0
s_cmp_ge_u32 s62, 6
s_cbranch_scc1 LWD_34
s_sleep 1
s_add_u32 s63, s63, 1
s_cmp_lt_u32 s63, 2400000
s_cbranch_scc1 LW_33
LWD_34:
s_mul_i32 s62, s61, 24576
s_add_u32 s62, s62, 24576
v_lshl_add_u32 v8, v0, 4, s62
ds_read_b128 v[32:35], v8 offset:0
ds_read_b128 v[36:39], v8 offset:1024
ds_read_b128 v[40:43], v8 offset:2048
ds_read_b128 v[44:47], v8 offset:3072
ds_read_b128 v[48:51], v8 offset:4096
ds_read_b128 v[52:55], v8 offset:5120
ds_read_b128 v[56:59], v8 offset:6144
ds_read_b128 v[60:63], v8 offset:7168
ds_read_b128 v[64:67], v8 offset:8192
ds_read_b128 v[68:71], v8 offset:9216
ds_read_b128 v[72:75], v8 offset:10240
ds_read_b128 v[76:79], v8 offset:11264
ds_read_b128 v[80:83], v8 offset:12288
ds_read_b128 v[84:87], v8 offset:13312
ds_read_b128 v[88:91], v8 offset:14336
ds_read_b128 v[92:95], v8 offset:15360
ds_read_b128 v[96:99], v8 offset:16384
ds_read_b128 v[100:103], v8 offset:17408
ds_read_b128 v[104:107], v8 offset:18432
ds_read_b128 v[108:111], v8 offset:19456
ds_read_b128 v[112:115], v8 offset:20480
ds_read_b128 v[116:119], v8 offset:21504
ds_read_b128 v[120:123], v8 offset:22528
ds_read_b128 v[124:127], v8 offset:23552
s_waitcnt lgkmcnt(0)
s_branch L_PV
L_F2:
s_cmp_ge_u32 s2, 240
s_cbranch_scc1 L_F2_NONE
s_mov_b32 s76, s2
s_lshr_b32 s68, s76, 2
s_and_b32 s69, s76, 3
v_lshlrev_b32 v7, 3, v0
s_mul_i32 s62, s69, 320
buffer_load_dwordx2 v[10:11], v7, s[36:39], s62 offen
v_lshrrev_b32 v8, 3, v0
v_and_b32 v9, 7, v0
v_bfe_u32 v6, v8, 1, 2
v_lshlrev_b32 v6, 1, v6
v_xor_b32 v9, v9, v6
v_mul_u32_u24 v8, 7680, v8
v_lshl_add_u32 v6, v9, 4, v8
s_mul_i32 s70, s69, 1228800
s_lshl_b32 s62, s68, 7
s_add_u32 s70, s70, s62
s_cbranch_execz DS_35
s_mov_b32 m0, 24576
s_nop 0
buffer_load_dwordx4 v6, s[40:43], s70 offen nt lds
s_add_u32 s70, s70, 61440
s_mov_b32 m0, 25600
s_nop 0
buffer_load_dwordx4 v6, s[40:43], s70 offen nt lds
s_add_u32 s70, s70, 61440
s_mov_b32 m0, 26624
s_nop 0
buffer_load_dwordx4 v6, s[40:43], s70 offen nt lds
s_add_u32 s70, s70, 61440
s_mov_b32 m0, 27648
s_nop 0
buffer_load_dwordx4 v6, s[40:43], s70 offen nt lds
s_add_u32 s70, s70, 61440
s_mov_b32 m0, 28672
s_nop 0
buffer_load_dwordx4 v6, s[40:43], s70 offen nt lds
s_add_u32 s70, s70, 61440
s_mov_b32 m0, 29696
s_nop 0
buffer_load_dwordx4 v6, s[40:43], s70 offen nt lds
s_add_u32 s70, s70, 61440
s_mov_b32 m0, 30720
s_nop 0
buffer_load_dwordx4 v6, s[40:43], s70 offen nt lds
s_add_u32 s70, s70, 61440
s_mov_b32 m0, 31744
s_nop 0
buffer_load_dwordx4 v6, s[40:43], s70 offen nt lds
s_add_u32 s70, s70, 61440
s_mov_b32 m0, 32768
s_nop 0
buffer_load_dwordx4 v6, s[40:43], s70 offen nt lds
s_add_u32 s70, s70, 61440
s_mov_b32 m0, 33792
s_nop 0
buffer_load_dwordx4 v6, s[40:43], s70 offen nt lds
s_add_u32 s70, s70, 61440
s_mov_b32 m0, 34816
s_nop 0
buffer_load_dwordx4 v6, s[40:43], s70 offen nt lds
s_add_u32 s70, s70, 61440
s_mov_b32 m0, 35840
s_nop 0
buffer_load_dwordx4 v6, s[40:43], s70 offen nt lds
s_add_u32 s70, s70, 61440
s_mov_b32 m0, 36864
s_nop 0
buffer_load_dwordx4 v6, s[40:43], s70 offen nt lds
s_add_u32 s70, s70, 61440
s_mov_b32 m0, 37888
s_nop 0
buffer_load_dwordx4 v6, s[40:43], s70 offen nt lds
s_add_u32 s70, s70, 61440
s_mov_b32 m0, 38912
s_nop 0
buffer_load_dwordx4 v6, s[40:43], s70 offen nt lds
s_add_u32 s70, s70, 61440
s_mov_b32 m0, 39936
s_nop 0
buffer_load_dwordx4 v6, s[40:43], s70 offen nt lds
s_add_u32 s70, s70, 61440
s_mov_b32 m0, 40960
s_nop 0
buffer_load_dwordx4 v6, s[40:43], s70 offen nt lds
s_add_u32 s70, s70, 61440
s_mov_b32 m0, 41984
s_nop 0
buffer_load_dwordx4 v6, s[40:43], s70 offen nt lds
s_add_u32 s70, s70, 61440
s_mov_b32 m0, 43008
s_nop 0
buffer_load_dwordx4 v6, s[40:43], s70 offen nt lds
s_add_u32 s70, s70, 61440
s_mov_b32 m0, 44032
s_nop 0
buffer_load_dwordx4 v6, s[40:43], s70 offen nt lds
DS_35:
s_barrier
s_waitcnt vmcnt(20)
v_lshlrev_b32 v12, 16, v10
v_and_b32 v13, 0xffff0000, v10
v_lshlrev_b32 v14, 16, v11
v_and_b32 v15, 0xffff0000, v11
s_mov_b32 s62, 3216550459
v_mul_f32 v16, s62, v12
v_mul_f32 v17, s62, v13
v_mul_f32 v18, s62, v14
v_mul_f32 v19, s62, v15
v_exp_f32 v16, v16
v_exp_f32 v17, v17
v_exp_f32 v18, v18
v_exp_f32 v19, v19
v_add_f32 v16, 1.0, v16
v_add_f32 v17, 1.0, v17
v_add_f32 v18, 1.0, v18
v_add_f32 v19, 1.0, v19
v_rcp_f32 v20, v16
s_nop 0
v_mul_f32 v21, v12, v20
v_fma_f32 v22, -v21, v16, v12
v_fma_f32 v23, v22, v20, v21
v_cmp_o_f32 vcc, v23, v23
s_nop 1
v_cndmask_b32 v12, v21, v23, vcc
v_rcp_f32 v20, v17
s_nop 0
v_mul_f32 v21, v13, v20
v_fma_f32 v22, -v21, v17, v13
v_fma_f32 v23, v22, v20, v21
v_cmp_o_f32 vcc, v23, v23
s_nop 1
v_cndmask_b32 v13, v21, v23, vcc
v_rcp_f32 v20, v18
s_nop 0
v_mul_f32 v21, v14, v20
v_fma_f32 v22, -v21, v18, v14
v_fma_f32 v23, v22, v20, v21
v_cmp_o_f32 vcc, v23, v23
s_nop 1
v_cndmask_b32 v14, v21, v23, vcc
v_rcp_f32 v20, v19
s_nop 0
v_mul_f32 v21, v15, v20
v_fma_f32 v22, -v21, v19, v15
v_fma_f32 v23, v22, v20, v21
v_cmp_o_f32 vcc, v23, v23
s_nop 1
v_cndmask_b32 v15, v21, v23, vcc
v_cvt_pk_bf16_f32 v16, v12, v13
v_cvt_pk_bf16_f32 v17, v14, v15
s_mov_b32 exec_lo, s3
s_and_b32 exec_hi, s3, 255
ds_write_b64 v7, v[16:17] offset:256
s_mov_b32 exec_lo, s3
s_mov_b32 exec_hi, s3
v_lshrrev_b32 v10, 2, v0
v_mul_u32_u24 v10, 128, v10
v_and_b32 v11, 3, v0
v_lshl_add_u32 v10, v11, 3, v10
v_add_u32 v10, 24576, v10
v_bfe_u32 v11, v0, 3, 2
v_xor_b32 v6, 0, v11
v_lshl_add_u32 v6, v6, 5, v10
v_xor_b32 v7, 1, v11
v_lshl_add_u32 v7, v7, 5, v10
v_xor_b32 v8, 2, v11
v_lshl_add_u32 v8, v8, 5, v10
v_xor_b32 v9, 3, v11
v_lshl_add_u32 v9, v9, 5, v10
v_lshrrev_b32 v10, 4, v0
v_lshlrev_b32 v10, 3, v10
ds_read2_b64 v[28:31], v10 offset0:32 offset1:36
ds_read2_b64 v[32:35], v10 offset0:40 offset1:44
ds_read2_b64 v[36:39], v10 offset0:48 offset1:52
ds_read2_b64 v[40:43], v10 offset0:56 offset1:60
ds_read2_b64 v[44:47], v10 offset0:64 offset1:68
v_and_b32 v11, 15, v0
v_lshlrev_b32 v11, 6, v11
v_lshrrev_b32 v12, 4, v0
v_lshl_add_u32 v11, v12, 4, v11
s_waitcnt vmcnt(10)
ds_write_b32 v3, v4 offset:44
s_waitcnt vmcnt(0)
ds_read_b64_tr_b16 v[48:49], v6 offset:0
ds_read_b64_tr_b16 v[50:51], v6 offset:2048
ds_read_b64_tr_b16 v[52:53], v7 offset:0
ds_read_b64_tr_b16 v[54:55], v7 offset:2048
ds_read_b64_tr_b16 v[56:57], v8 offset:0
ds_read_b64_tr_b16 v[58:59], v8 offset:2048
ds_read_b64_tr_b16 v[60:61], v9 offset:0
ds_read_b64_tr_b16 v[62:63], v9 offset:2048
ds_read_b64_tr_b16 v[64:65], v6 offset:4096
ds_read_b64_tr_b16 v[66:67], v6 offset:6144
ds_read_b64_tr_b16 v[68:69], v7 offset:4096
ds_read_b64_tr_b16 v[70:71], v7 offset:6144
ds_read_b64_tr_b16 v[72:73], v8 offset:4096
ds_read_b64_tr_b16 v[74:75], v8 offset:6144
ds_read_b64_tr_b16 v[76:77], v9 offset:4096
ds_read_b64_tr_b16 v[78:79], v9 offset:6144
ds_read_b64_tr_b16 v[80:81], v6 offset:8192
ds_read_b64_tr_b16 v[82:83], v6 offset:10240
ds_read_b64_tr_b16 v[84:85], v7 offset:8192
ds_read_b64_tr_b16 v[86:87], v7 offset:10240
ds_read_b64_tr_b16 v[88:89], v8 offset:8192
ds_read_b64_tr_b16 v[90:91], v8 offset:10240
ds_read_b64_tr_b16 v[92:93], v9 offset:8192
ds_read_b64_tr_b16 v[94:95], v9 offset:10240
ds_read_b64_tr_b16 v[96:97], v6 offset:12288
ds_read_b64_tr_b16 v[98:99], v6 offset:14336
ds_read_b64_tr_b16 v[100:101], v7 offset:12288
ds_read_b64_tr_b16 v[102:103], v7 offset:14336
ds_read_b64_tr_b16 v[104:105], v8 offset:12288
ds_read_b64_tr_b16 v[106:107], v8 offset:14336
ds_read_b64_tr_b16 v[108:109], v9 offset:12288
ds_read_b64_tr_b16 v[110:111], v9 offset:14336
ds_read_b64_tr_b16 v[112:113], v6 offset:16384
ds_read_b64_tr_b16 v[114:115], v6 offset:18432
ds_read_b64_tr_b16 v[116:117], v7 offset:16384
ds_read_b64_tr_b16 v[118:119], v7 offset:18432
ds_read_b64_tr_b16 v[120:121], v8 offset:16384
ds_read_b64_tr_b16 v[122:123], v8 offset:18432
ds_read_b64_tr_b16 v[124:125], v9 offset:16384
ds_read_b64_tr_b16 v[126:127], v9 offset:18432
v_mov_b32 v12, 0
v_mov_b32 v13, 0
v_mov_b32 v14, 0
v_mov_b32 v15, 0
v_mov_b32 v16, 0
v_mov_b32 v17, 0
v_mov_b32 v18, 0
v_mov_b32 v19, 0
v_mov_b32 v20, 0
v_mov_b32 v21, 0
v_mov_b32 v22, 0
v_mov_b32 v23, 0
v_mov_b32 v24, 0
v_mov_b32 v25, 0
v_mov_b32 v26, 0
v_mov_b32 v27, 0
s_waitcnt lgkmcnt(0)
s_and_b32 exec_lo, s3, 1
s_mov_b32 exec_hi, 0
ds_add_u32 v3, v4 offset:28
s_mov_b32 exec_lo, s3
s_mov_b32 exec_hi, s3
v_mfma_f32_16x16x32_bf16 v[12:15], v[48:51], v[28:31], v[12:15]
v_mfma_f32_16x16x32_bf16 v[16:19], v[52:55], v[28:31], v[16:19]
v_mfma_f32_16x16x32_bf16 v[20:23], v[56:59], v[28:31], v[20:23]
v_mfma_f32_16x16x32_bf16 v[24:27], v[60:63], v[28:31], v[24:27]
v_mfma_f32_16x16x32_bf16 v[12:15], v[64:67], v[32:35], v[12:15]
v_mfma_f32_16x16x32_bf16 v[16:19], v[68:71], v[32:35], v[16:19]
v_mfma_f32_16x16x32_bf16 v[20:23], v[72:75], v[32:35], v[20:23]
v_mfma_f32_16x16x32_bf16 v[24:27], v[76:79], v[32:35], v[24:27]
v_mfma_f32_16x16x32_bf16 v[12:15], v[80:83], v[36:39], v[12:15]
v_mfma_f32_16x16x32_bf16 v[16:19], v[84:87], v[36:39], v[16:19]
v_mfma_f32_16x16x32_bf16 v[20:23], v[88:91], v[36:39], v[20:23]
v_mfma_f32_16x16x32_bf16 v[24:27], v[92:95], v[36:39], v[24:27]
v_mfma_f32_16x16x32_bf16 v[12:15], v[96:99], v[40:43], v[12:15]
v_mfma_f32_16x16x32_bf16 v[16:19], v[100:103], v[40:43], v[16:19]
v_mfma_f32_16x16x32_bf16 v[20:23], v[104:107], v[40:43], v[20:23]
v_mfma_f32_16x16x32_bf16 v[24:27], v[108:111], v[40:43], v[24:27]
v_mfma_f32_16x16x32_bf16 v[12:15], v[112:115], v[44:47], v[12:15]
v_mfma_f32_16x16x32_bf16 v[16:19], v[116:119], v[44:47], v[16:19]
v_mfma_f32_16x16x32_bf16 v[20:23], v[120:123], v[44:47], v[20:23]
v_mfma_f32_16x16x32_bf16 v[24:27], v[124:127], v[44:47], v[24:27]
s_lshl_b32 s70, s76, 9
s_add_u32 s70, s70, 917504
s_mov_b32 s63, 0
s_cbranch_execz LWD_37
LW_36:
ds_read_b32 v49, v3 offset:0
s_waitcnt lgkmcnt(0)
v_readfirstlane_b32 s62, v49
s_nop 0
s_cmp_lg_u32 s62, 0
s_cbranch_scc1 LWD_37
s_sleep 1
s_add_u32 s63, s63, 1
s_cmp_lt_u32 s63, 2400000
s_cbranch_scc1 LW_36
LWD_37:
s_mov_b32 s79, s62
v_mov_b32 v52, v12
v_mov_b32 v53, v13
v_mov_b32 v54, v14
v_mov_b32 v55, v15
s_mov_b32 s80, 131074
s_mov_b32 s81, 131074
v_cndmask_b32 v52, v52, v16, s[80:81]
v_cndmask_b32 v53, v53, v17, s[80:81]
v_cndmask_b32 v54, v54, v18, s[80:81]
v_cndmask_b32 v55, v55, v19, s[80:81]
s_mov_b32 s80, 262148
s_mov_b32 s81, 262148
v_cndmask_b32 v52, v52, v20, s[80:81]
v_cndmask_b32 v53, v53, v21, s[80:81]
v_cndmask_b32 v54, v54, v22, s[80:81]
v_cndmask_b32 v55, v55, v23, s[80:81]
s_mov_b32 s80, 524296
s_mov_b32 s81, 524296
v_cndmask_b32 v52, v52, v24, s[80:81]
v_cndmask_b32 v53, v53, v25, s[80:81]
v_cndmask_b32 v54, v54, v26, s[80:81]
v_cndmask_b32 v55, v55, v27, s[80:81]
v_mov_b32 v56, v52
v_mov_b32 v58, v53
v_mov_b32 v60, v54
v_mov_b32 v62, v55
v_mov_b32 v57, s79
v_mov_b32 v59, s79
v_mov_b32 v61, s79
v_mov_b32 v63, s79
s_and_b32 exec_lo, s3, 983055
s_and_b32 exec_hi, s3, 983055
buffer_store_dwordx4 v[56:59], v11, s[52:55], s70 offen sc1
buffer_store_dwordx4 v[60:63], v11, s[52:55], s70 offen offset:256 sc1
s_mov_b32 exec_lo, s3
s_mov_b32 exec_hi, s3
s_branch L_VSTREAM
L_F2_NONE:
s_barrier
ds_write_b32 v3, v4 offset:44
s_and_b32 exec_lo, s3, 1
s_mov_b32 exec_hi, 0
ds_add_u32 v3, v4 offset:28
s_mov_b32 exec_lo, s3
s_mov_b32 exec_hi, s3
s_branch L_VSTREAM
L_F3:
s_cmp_ge_u32 s61, 4
s_cbranch_scc1 L_F4
s_cmp_lg_u32 s2, 0
s_cbranch_scc1 L_F3_B
s_memrealtime s[62:63]
s_waitcnt lgkmcnt(0)
s_or_b32 s62, s62, 1
v_mov_b32 v8, s62
s_and_b32 exec_lo, s3, 1
s_mov_b32 exec_hi, 0
v_mov_b32 v9, 0
buffer_atomic_cmpswap v[8:9], v3, s[48:51], 0 offen sc1
s_mov_b32 exec_lo, s3
s_mov_b32 exec_hi, s3
L_F3_B:
v_lshlrev_b32 v7, 2, v0
ds_write_b32 v7, v3
ds_write_b32 v7, v3 offset:4096
ds_write_b32 v7, v3 offset:4352
ds_write_b32 v7, v3 offset:4608
s_waitcnt lgkmcnt(0)
s_barrier
s_and_b32 exec_lo, s3, 1
s_mov_b32 exec_hi, 0
s_mov_b32 s63, 0
PL_38:
buffer_load_dword v9, v3, s[48:51], 0 offen sc1
s_waitcnt vmcnt(0)
v_mov_b32 v10, v9
v_cmp_eq_u32 vcc, 0, v10
s_cbranch_vccz PD_39
s_sleep 4
s_add_u32 s63, s63, 1
s_cmp_lt_u32 s63, 300000
s_cbranch_scc1 PL_38
PD_39:
ds_write_b32 v3, v9 offset:0
s_mov_b32 exec_lo, s3
s_mov_b32 exec_hi, s3
s_branch L_VSTREAM
L_F4:
s_cmp_lg_u32 s61, 4
s_cbranch_scc1 L_F5
v_mov_b32 v8, 0
v_mov_b32 v9, 0
v_mov_b32 v10, 0
v_mov_b32 v11, 0
s_mul_i32 s68, s58, 43
s_lshr_b32 s68, s68, 8
s_mul_i32 s62, s68, 6
s_sub_u32 s69, s58, s62
s_mul_i32 s70, s68, 24576
s_mul_i32 s62, s57, 3072
s_add_u32 s70, s70, s62
s_lshl_b32 s62, s69, 9
s_add_u32 s70, s70, s62
s_add_u32 s70, s70, 131072
v_and_b32 v12, 31, v0
v_lshlrev_b32 v12, 4, v12
v_lshrrev_b32 v13, 5, v0
v_mul_u32_u24 v13, 131072, v13
v_add_u32 v12, v12, v13
s_cmp_ge_u32 s58, 30
s_cbranch_scc1 L_F4_B
s_mov_b32 exec_lo, s3
s_mov_b32 exec_hi, 0
buffer_store_dwordx4 v[8:11], v12, s[52:55], s70 offen sc1
s_mov_b32 exec_lo, s3
s_mov_b32 exec_hi, s3
L_F4_B:
s_lshl_b32 s62, s59, 3
s_add_u32 s62, s62, s60
s_mul_i32 s71, s62, 768
s_lshl_b32 s72, s62, 6
v_lshlrev_b32 v12, 4, v0
s_add_u32 s73, s71, 458752
v_add_u32 v13, s73, v12
s_add_u32 s73, s72, 392448
v_add_u32 v14, s73, v12
v_cmp_lt_u32 vcc, 47, v0
s_nop 1
v_cndmask_b32 v13, v13, v14, vcc
s_add_u32 s73, s71, 655360
v_add_u32 v15, s73, v12
s_add_u32 s73, s72, 408832
v_add_u32 v14, s73, v12
v_cndmask_b32 v15, v15, v14, vcc
s_cmp_ge_u32 s58, 20
s_cbranch_scc1 L_F4_C
s_and_b32 s62, s58, 1
s_lshl_b32 s63, s57, 1
s_add_u32 s62, s62, s63
s_mul_i32 s74, s62, 2560
s_lshr_b32 s62, s58, 1
s_lshl_b32 s62, s62, 8
s_add_u32 s74, s74, s62
s_add_u32 s74, s74, 0
s_and_b32 exec_lo, s3, 65535
s_mov_b32 exec_hi, 0
buffer_store_dwordx4 v[8:11], v12, s[52:55], s74 offen sc1
s_mov_b32 exec_lo, s3
s_mov_b32 exec_hi, s3
s_branch L_F4_D
L_F4_C:
s_cmp_ge_u32 s57, 4
s_cbranch_scc1 L_F4_D
s_mul_i32 s75, s57, 12
s_add_u32 s75, s75, s58
s_sub_u32 s75, s75, 20
s_and_b32 s62, s75, 1
s_mul_i32 s74, s62, 3072
s_lshr_b32 s62, s75, 1
s_lshl_b32 s62, s62, 7
s_add_u32 s74, s74, s62
s_add_u32 s74, s74, 65536
s_and_b32 exec_lo, s3, 255
s_mov_b32 exec_hi, 0
buffer_store_dwordx4 v[8:11], v12, s[52:55], s74 offen sc1
s_mov_b32 exec_lo, s3
s_mov_b32 exec_hi, s3
s_cmp_ge_u32 s75, 8
s_cbranch_scc1 L_F4_D
s_mul_i32 s63, s75, 160
s_add_u32 s63, s63, 73728
s_and_b32 exec_lo, s3, 1023
s_mov_b32 exec_hi, 0
buffer_store_dwordx4 v[8:11], v12, s[52:55], s63 offen sc1
s_mov_b32 exec_lo, s3
s_mov_b32 exec_hi, s3
L_F4_D:
s_mov_b32 exec_lo, s3
s_and_b32 exec_hi, s3, 1048575
buffer_store_dwordx4 v[8:11], v13, s[52:55], 0 offen sc1
s_mov_b32 exec_lo, s3
s_mov_b32 exec_hi, s3
s_barrier
s_waitcnt vmcnt(0)
ds_write_b32 v3, v4 offset:16
s_mov_b32 s63, 0
s_cbranch_execz LWD_41
LW_40:
ds_read_b32 v12, v3 offset:0
s_waitcnt lgkmcnt(0)
v_readfirstlane_b32 s62, v12
s_nop 0
s_cmp_lg_u32 s62, 0
s_cbranch_scc1 LWD_41
s_sleep 1
s_add_u32 s63, s63, 1
s_cmp_lt_u32 s63, 2400000
s_cbranch_scc1 LW_40
LWD_41:
s_mov_b32 s79, s62
v_mov_b32 v12, s79
s_getreg_b32 s62, hwreg(HW_REG_XCC_ID)
s_and_b32 s62, s62, 15
s_add_u32 s62, s62, 1
v_mov_b32 v13, s62
s_lshl_b32 s70, s57, 5
s_add_u32 s70, s70, s58
s_lshl_b32 s70, s70, 3
s_add_u32 s70, s70, 98304
s_and_b32 exec_lo, s3, 1
s_mov_b32 exec_hi, 0
buffer_store_dwordx2 v[12:13], v3, s[52:55], s70 offen sc1
s_mov_b32 exec_lo, s3
s_mov_b32 exec_hi, s3
s_branch L_VSTREAM
L_F5:
s_barrier
s_cmp_lg_u32 s61, 5
s_cbranch_scc1 L_F6
s_cmp_ge_u32 s2, 40
s_cbranch_scc1 L_F6
s_mov_b32 s76, s2
v_lshrrev_b32 v8, 4, v0
v_lshlrev_b32 v8, 9, v8
v_and_b32 v9, 15, v0
v_lshlrev_b32 v9, 4, v9
v_add_u32 v8, v8, v9
s_lshl_b32 s64, s76, 11
s_add_u32 s64, s64, 958464
s_lshl_b32 s72, s76, 8
s_add_u32 s72, s72, 106496
s_mov_b32 s63, 0
s_cbranch_execz LWD_43
LW_42:
ds_read_b32 v10, v3 offset:0
s_waitcnt lgkmcnt(0)
v_readfirstlane_b32 s62, v10
s_nop 0
s_cmp_lg_u32 s62, 0
s_cbranch_scc1 LWD_43
s_sleep 1
s_add_u32 s63, s63, 1
s_cmp_lt_u32 s63, 2400000
s_cbranch_scc1 LW_42
LWD_43:
s_mov_b32 s79, s62
s_mov_b32 s63, 0
PL_44:
buffer_load_dwordx4 v[12:15], v8, s[52:55], s64 offen sc1
buffer_load_dwordx4 v[16:19], v8, s[52:55], s64 offen offset:256 sc1
s_waitcnt vmcnt(0)
v_xor_b32 v10, s79, v13
v_xor_b32 v15, s79, v15
v_xor_b32 v17, s79, v17
v_xor_b32 v19, s79, v19
v_or3_b32 v10, v10, v15, v17
v_or_b32 v10, v10, v19
v_cmp_ne_u32 vcc, 0, v10
s_cbranch_vccz PD_45
s_sleep 8
s_add_u32 s63, s63, 1
s_cmp_lt_u32 s63, 300000
s_cbranch_scc1 PL_44
PD_45:
v_mov_b32 v13, v12
v_mov_b32 v15, v14
v_mov_b32 v17, v16
v_mov_b32 v19, v18
v_permlane16_swap_b32 v12, v13
v_permlane16_swap_b32 v14, v15
v_permlane16_swap_b32 v16, v17
v_permlane16_swap_b32 v18, v19
v_add_f32 v12, v12, v13
v_add_f32 v14, v14, v15
v_add_f32 v16, v16, v17
v_add_f32 v18, v18, v19
v_mov_b32 v13, v12
v_mov_b32 v15, v14
v_mov_b32 v17, v16
v_mov_b32 v19, v18
v_permlane32_swap_b32 v12, v13
v_permlane32_swap_b32 v14, v15
v_permlane32_swap_b32 v16, v17
v_permlane32_swap_b32 v18, v19
v_add_f32 v12, v12, v13
v_add_f32 v14, v14, v15
v_add_f32 v16, v16, v17
v_add_f32 v18, v18, v19
v_cvt_pk_bf16_f32 v20, v12, v14
v_cvt_pk_bf16_f32 v22, v16, v18
v_mov_b32 v21, s79
v_mov_b32 v23, s79
s_and_b32 exec_lo, s3, 65535
s_mov_b32 exec_hi, 0
buffer_store_dwordx4 v[20:23], v9, s[52:55], s72 offen sc1
s_mov_b32 exec_lo, s3
s_mov_b32 exec_hi, s3
L_F6:
L_DRYRET:
L_VSTREAM:
s_waitcnt vmcnt(0)
s_sub_u32 s68, s61, 2
s_cmp_ge_u32 s68, 3
s_cselect_b32 s69, 1, 0
s_mul_i32 s62, s69, 3
s_sub_u32 s68, s68, s62
s_mul_i32 s70, s69, 24576
s_add_u32 s71, s70, 24576
s_add_u32 s70, s70, s67
s_lshl_b32 s62, s68, 13
s_add_u32 s71, s71, s62
s_mov_b32 s63, 0
s_cbranch_execz LWD_47
LW_46:
ds_read_b32 v6, v3 offset:28
s_waitcnt lgkmcnt(0)
v_readfirstlane_b32 s62, v6
s_nop 0
s_cmp_ge_u32 s62, 3
s_cbranch_scc1 LWD_47
s_sleep 1
s_add_u32 s63, s63, 1
s_cmp_lt_u32 s63, 2400000
s_cbranch_scc1 LW_46
LWD_47:
s_mov_b32 s63, 0
s_cbranch_execz LWD_49
LW_48:
ds_read_b32 v6, v5 offset:64
s_waitcnt lgkmcnt(0)
v_readfirstlane_b32 s62, v6
s_nop 0
s_cmp_lg_u32 s62, 0
s_cbranch_scc1 LWD_49
s_sleep 1
s_add_u32 s63, s63, 1
s_cmp_lt_u32 s63, 2400000
s_cbranch_scc1 LW_48
LWD_49:
s_lshl_b32 s68, s68, 3
s_mov_b32 s69, 0
s_mov_b32 s74, 0
s_mov_b32 s75, 0
L_VP:
s_lshl_b32 s62, s68, 7
s_cmp_ge_u32 s68, 12
s_cselect_b32 s63, 10752, 0
s_add_u32 s62, s62, s63
s_add_u32 s62, s62, s70
s_mov_b32 m0, s71
s_nop 0
buffer_load_dwordx4 v2, s[12:15], s62 offen nt lds
s_add_u32 s71, s71, 1024
s_add_u32 s68, s68, 1
s_add_u32 s69, s69, 1
s_cmp_lg_u32 s74, 0
s_cbranch_scc1 L_VP_N
ds_read_b32 v6, v5 offset:128
s_waitcnt vmcnt(3) lgkmcnt(0)
v_readfirstlane_b32 s74, v6
L_VP_N:
s_cmp_lt_u32 s69, 8
s_cbranch_scc1 L_VP
s_cmp_lg_u32 s74, 0
s_cbranch_scc1 L_VF_0
buffer_load_dwordx4 v[32:35], v2, s[12:15], s65 offen offset:0 nt
ds_read_b32 v6, v5 offset:128
s_waitcnt vmcnt(3) lgkmcnt(0)
v_readfirstlane_b32 s62, v6
s_nop 0
s_cmp_lg_u32 s62, 0
s_cbranch_scc1 L_VF_1
buffer_load_dwordx4 v[36:39], v2, s[12:15], s65 offen offset:128 nt
ds_read_b32 v6, v5 offset:128
s_waitcnt vmcnt(3) lgkmcnt(0)
v_readfirstlane_b32 s62, v6
s_nop 0
s_cmp_lg_u32 s62, 0
s_cbranch_scc1 L_VF_2
buffer_load_dwordx4 v[40:43], v2, s[12:15], s65 offen offset:256 nt
ds_read_b32 v6, v5 offset:128
s_waitcnt vmcnt(3) lgkmcnt(0)
v_readfirstlane_b32 s62, v6
s_nop 0
s_cmp_lg_u32 s62, 0
s_cbranch_scc1 L_VF_3
buffer_load_dwordx4 v[44:47], v2, s[12:15], s65 offen offset:384 nt
ds_read_b32 v6, v5 offset:128
s_waitcnt vmcnt(3) lgkmcnt(0)
s_and_b32 exec_lo, s3, 1
s_mov_b32 exec_hi, 0
ds_add_u32 v3, v4 offset:32
s_mov_b32 exec_lo, s3
s_mov_b32 exec_hi, s3
s_mov_b32 s75, 1
v_readfirstlane_b32 s62, v6
s_nop 0
s_cmp_lg_u32 s62, 0
s_cbranch_scc1 L_VF_4
buffer_load_dwordx4 v[48:51], v2, s[12:15], s65 offen offset:512 nt
ds_read_b32 v6, v5 offset:128
s_waitcnt vmcnt(3) lgkmcnt(0)
v_readfirstlane_b32 s62, v6
s_nop 0
s_cmp_lg_u32 s62, 0
s_cbranch_scc1 L_VF_5
buffer_load_dwordx4 v[52:55], v2, s[12:15], s65 offen offset:640 nt
ds_read_b32 v6, v5 offset:128
s_waitcnt vmcnt(3) lgkmcnt(0)
v_readfirstlane_b32 s62, v6
s_nop 0
s_cmp_lg_u32 s62, 0
s_cbranch_scc1 L_VF_6
buffer_load_dwordx4 v[56:59], v2, s[12:15], s65 offen offset:768 nt
ds_read_b32 v6, v5 offset:128
s_waitcnt vmcnt(3) lgkmcnt(0)
v_readfirstlane_b32 s62, v6
s_nop 0
s_cmp_lg_u32 s62, 0
s_cbranch_scc1 L_VF_7
buffer_load_dwordx4 v[60:63], v2, s[12:15], s65 offen offset:896 nt
ds_read_b32 v6, v5 offset:128
s_waitcnt vmcnt(3) lgkmcnt(0)
v_readfirstlane_b32 s62, v6
s_nop 0
s_cmp_lg_u32 s62, 0
s_cbranch_scc1 L_VF_8
buffer_load_dwordx4 v[64:67], v2, s[12:15], s65 offen offset:1024 nt
ds_read_b32 v6, v5 offset:128
s_waitcnt vmcnt(3) lgkmcnt(0)
v_readfirstlane_b32 s62, v6
s_nop 0
s_cmp_lg_u32 s62, 0
s_cbranch_scc1 L_VF_9
buffer_load_dwordx4 v[68:71], v2, s[12:15], s65 offen offset:1152 nt
ds_read_b32 v6, v5 offset:128
s_waitcnt vmcnt(3) lgkmcnt(0)
v_readfirstlane_b32 s62, v6
s_nop 0
s_cmp_lg_u32 s62, 0
s_cbranch_scc1 L_VF_10
buffer_load_dwordx4 v[72:75], v2, s[12:15], s65 offen offset:1280 nt
ds_read_b32 v6, v5 offset:128
s_waitcnt vmcnt(3) lgkmcnt(0)
v_readfirstlane_b32 s62, v6
s_nop 0
s_cmp_lg_u32 s62, 0
s_cbranch_scc1 L_VF_11
buffer_load_dwordx4 v[76:79], v2, s[12:15], s65 offen offset:1408 nt
ds_read_b32 v6, v5 offset:128
s_waitcnt vmcnt(3) lgkmcnt(0)
v_readfirstlane_b32 s62, v6
s_nop 0
s_cmp_lg_u32 s62, 0
s_cbranch_scc1 L_VF_12
buffer_load_dwordx4 v[80:83], v2, s[12:15], s66 offen offset:0 nt
ds_read_b32 v6, v5 offset:128
s_waitcnt vmcnt(3) lgkmcnt(0)
v_readfirstlane_b32 s62, v6
s_nop 0
s_cmp_lg_u32 s62, 0
s_cbranch_scc1 L_VF_13
buffer_load_dwordx4 v[84:87], v2, s[12:15], s66 offen offset:128 nt
ds_read_b32 v6, v5 offset:128
s_waitcnt vmcnt(3) lgkmcnt(0)
v_readfirstlane_b32 s62, v6
s_nop 0
s_cmp_lg_u32 s62, 0
s_cbranch_scc1 L_VF_14
buffer_load_dwordx4 v[88:91], v2, s[12:15], s66 offen offset:256 nt
ds_read_b32 v6, v5 offset:128
s_waitcnt vmcnt(3) lgkmcnt(0)
v_readfirstlane_b32 s62, v6
s_nop 0
s_cmp_lg_u32 s62, 0
s_cbranch_scc1 L_VF_15
buffer_load_dwordx4 v[92:95], v2, s[12:15], s66 offen offset:384 nt
ds_read_b32 v6, v5 offset:128
s_waitcnt vmcnt(3) lgkmcnt(0)
v_readfirstlane_b32 s62, v6
s_nop 0
s_cmp_lg_u32 s62, 0
s_cbranch_scc1 L_VF_16
buffer_load_dwordx4 v[96:99], v2, s[12:15], s66 offen offset:512 nt
ds_read_b32 v6, v5 offset:128
s_waitcnt vmcnt(3) lgkmcnt(0)
v_readfirstlane_b32 s62, v6
s_nop 0
s_cmp_lg_u32 s62, 0
s_cbranch_scc1 L_VF_17
buffer_load_dwordx4 v[100:103], v2, s[12:15], s66 offen offset:640 nt
ds_read_b32 v6, v5 offset:128
s_waitcnt vmcnt(3) lgkmcnt(0)
v_readfirstlane_b32 s62, v6
s_nop 0
s_cmp_lg_u32 s62, 0
s_cbranch_scc1 L_VF_18
buffer_load_dwordx4 v[104:107], v2, s[12:15], s66 offen offset:768 nt
ds_read_b32 v6, v5 offset:128
s_waitcnt vmcnt(3) lgkmcnt(0)
v_readfirstlane_b32 s62, v6
s_nop 0
s_cmp_lg_u32 s62, 0
s_cbranch_scc1 L_VF_19
buffer_load_dwordx4 v[108:111], v2, s[12:15], s66 offen offset:896 nt
ds_read_b32 v6, v5 offset:128
s_waitcnt vmcnt(3) lgkmcnt(0)
v_readfirstlane_b32 s62, v6
s_nop 0
s_cmp_lg_u32 s62, 0
s_cbranch_scc1 L_VF_20
buffer_load_dwordx4 v[112:115], v2, s[12:15], s66 offen offset:1024 nt
ds_read_b32 v6, v5 offset:128
s_waitcnt vmcnt(3) lgkmcnt(0)
v_readfirstlane_b32 s62, v6
s_nop 0
s_cmp_lg_u32 s62, 0
s_cbranch_scc1 L_VF_21
buffer_load_dwordx4 v[116:119], v2, s[12:15], s66 offen offset:1152 nt
ds_read_b32 v6, v5 offset:128
s_waitcnt vmcnt(3) lgkmcnt(0)
v_readfirstlane_b32 s62, v6
s_nop 0
s_cmp_lg_u32 s62, 0
s_cbranch_scc1 L_VF_22
buffer_load_dwordx4 v[120:123], v2, s[12:15], s66 offen offset:1280 nt
ds_read_b32 v6, v5 offset:128
s_waitcnt vmcnt(3) lgkmcnt(0)
v_readfirstlane_b32 s62, v6
s_nop 0
s_cmp_lg_u32 s62, 0
s_cbranch_scc1 L_VF_23
buffer_load_dwordx4 v[124:127], v2, s[12:15], s66 offen offset:1408 nt
s_branch L_VF_E
L_VF_0:
buffer_load_dwordx4 v[32:35], v2, s[12:15], s65 offen offset:0 nt
L_VF_1:
buffer_load_dwordx4 v[36:39], v2, s[12:15], s65 offen offset:128 nt
L_VF_2:
buffer_load_dwordx4 v[40:43], v2, s[12:15], s65 offen offset:256 nt
L_VF_3:
buffer_load_dwordx4 v[44:47], v2, s[12:15], s65 offen offset:384 nt
L_VF_4:
buffer_load_dwordx4 v[48:51], v2, s[12:15], s65 offen offset:512 nt
L_VF_5:
buffer_load_dwordx4 v[52:55], v2, s[12:15], s65 offen offset:640 nt
L_VF_6:
buffer_load_dwordx4 v[56:59], v2, s[12:15], s65 offen offset:768 nt
L_VF_7:
buffer_load_dwordx4 v[60:63], v2, s[12:15], s65 offen offset:896 nt
L_VF_8:
buffer_load_dwordx4 v[64:67], v2, s[12:15], s65 offen offset:1024 nt
L_VF_9:
buffer_load_dwordx4 v[68:71], v2, s[12:15], s65 offen offset:1152 nt
L_VF_10:
buffer_load_dwordx4 v[72:75], v2, s[12:15], s65 offen offset:1280 nt
L_VF_11:
buffer_load_dwordx4 v[76:79], v2, s[12:15], s65 offen offset:1408 nt
L_VF_12:
buffer_load_dwordx4 v[80:83], v2, s[12:15], s66 offen offset:0 nt
L_VF_13:
buffer_load_dwordx4 v[84:87], v2, s[12:15], s66 offen offset:128 nt
L_VF_14:
buffer_load_dwordx4 v[88:91], v2, s[12:15], s66 offen offset:256 nt
L_VF_15:
buffer_load_dwordx4 v[92:95], v2, s[12:15], s66 offen offset:384 nt
L_VF_16:
buffer_load_dwordx4 v[96:99], v2, s[12:15], s66 offen offset:512 nt
L_VF_17:
buffer_load_dwordx4 v[100:103], v2, s[12:15], s66 offen offset:640 nt
L_VF_18:
buffer_load_dwordx4 v[104:107], v2, s[12:15], s66 offen offset:768 nt
L_VF_19:
buffer_load_dwordx4 v[108:111], v2, s[12:15], s66 offen offset:896 nt
L_VF_20:
buffer_load_dwordx4 v[112:115], v2, s[12:15], s66 offen offset:1024 nt
L_VF_21:
buffer_load_dwordx4 v[116:119], v2, s[12:15], s66 offen offset:1152 nt
L_VF_22:
buffer_load_dwordx4 v[120:123], v2, s[12:15], s66 offen offset:1280 nt
L_VF_23:
buffer_load_dwordx4 v[124:127], v2, s[12:15], s66 offen offset:1408 nt
s_cmp_lg_u32 s75, 0
s_cbranch_scc1 L_VF_E
s_and_b32 exec_lo, s3, 1
s_mov_b32 exec_hi, 0
ds_add_u32 v3, v4 offset:96
s_mov_b32 exec_lo, s3
s_mov_b32 exec_hi, s3
s_waitcnt vmcnt(24)
s_and_b32 exec_lo, s3, 1
s_mov_b32 exec_hi, 0
ds_add_u32 v3, v4 offset:32
s_mov_b32 exec_lo, s3
s_mov_b32 exec_hi, s3
s_branch L_VF_E2
L_VF_E:
s_and_b32 exec_lo, s3, 1
s_mov_b32 exec_hi, 0
ds_add_u32 v3, v4 offset:96
s_mov_b32 exec_lo, s3
s_mov_b32 exec_hi, s3
L_VF_E2:
L_PV:
v_and_b32 v14, 7, v0
v_and_b32 v15, 1, v14
v_lshlrev_b32 v15, 4, v15
v_mov_b32 v10, 0xffff
v_lshlrev_b32 v15, v15, v10
v_lshrrev_b32 v14, 1, v14
v_cmp_eq_u32 vcc, 0, v14
s_nop 1
v_cndmask_b32 v6, 0, v15, vcc
v_cmp_eq_u32 vcc, 1, v14
s_nop 1
v_cndmask_b32 v7, 0, v15, vcc
v_cmp_eq_u32 vcc, 2, v14
s_nop 1
v_cndmask_b32 v8, 0, v15, vcc
v_cmp_eq_u32 vcc, 3, v14
s_nop 1
v_cndmask_b32 v9, 0, v15, vcc
v_mov_b32 v16, 0
v_mov_b32 v17, 0
v_mov_b32 v18, 0
v_mov_b32 v19, 0
v_mov_b32 v20, 0
v_mov_b32 v21, 0
v_mov_b32 v22, 0
v_mov_b32 v23, 0
v_mov_b32 v24, 0
v_mov_b32 v25, 0
v_mov_b32 v26, 0
v_mov_b32 v27, 0
v_lshrrev_b32 v14, 3, v0
v_lshlrev_b32 v14, 4, v14
s_lshl_b32 s62, s61, 8
v_add_u32 v14, s62, v14
v_bfe_u32 v1, v0, 4, 1
v_lshlrev_b32 v1, 7, v1
v_and_b32 v15, 7, v0
v_lshl_add_u32 v1, v15, 2, v1
v_lshrrev_b32 v15, 5, v0
v_lshl_add_u32 v1, v15, 5, v1
s_mul_i32 s62, s61, 768
v_add_u32 v1, s62, v1
s_lshl_b32 s62, s59, 3
s_add_u32 s62, s62, s60
s_mul_i32 s62, s62, 768
s_add_u32 s72, s62, 458752
s_mov_b32 s63, 0
s_cbranch_execz LWD_51
LW_50:
ds_read_b32 v15, v5 offset:128
s_waitcnt lgkmcnt(0)
v_readfirstlane_b32 s62, v15
s_nop 0
s_cmp_lg_u32 s62, 0
s_cbranch_scc1 LWD_51
s_sleep 1
s_add_u32 s63, s63, 1
s_cmp_lt_u32 s63, 2400000
s_cbranch_scc1 LW_50
LWD_51:
s_mov_b32 s63, 0
s_cbranch_execz LWD_53
LW_52:
ds_read_b32 v15, v3 offset:60
s_waitcnt lgkmcnt(0)
v_readfirstlane_b32 s62, v15
s_nop 0
s_cmp_lg_u32 s62, 0
s_cbranch_scc1 LWD_53
s_sleep 1
s_add_u32 s63, s63, 1
s_cmp_lt_u32 s63, 2400000
s_cbranch_scc1 LW_52
LWD_53:
s_mov_b32 s73, s62
ds_read_b128 v[10:13], v14 offset:2048
s_waitcnt lgkmcnt(0)
v_and_b32 v28, v10, v6
v_and_b32 v29, v10, v7
v_and_b32 v30, v10, v8
v_and_b32 v31, v10, v9
s_waitcnt vmcnt(23)
s_nop 0
v_mfma_f32_16x16x32_bf16 v[16:19], v[32:35], v[28:31], v[16:19]
s_waitcnt vmcnt(22)
v_mfma_f32_16x16x32_bf16 v[20:23], v[36:39], v[28:31], v[20:23]
s_waitcnt vmcnt(21)
v_mfma_f32_16x16x32_bf16 v[24:27], v[40:43], v[28:31], v[24:27]
v_and_b32 v28, v11, v6
v_and_b32 v29, v11, v7
v_and_b32 v30, v11, v8
v_and_b32 v31, v11, v9
s_waitcnt vmcnt(20)
s_nop 0
v_mfma_f32_16x16x32_bf16 v[16:19], v[44:47], v[28:31], v[16:19]
s_waitcnt vmcnt(19)
v_mfma_f32_16x16x32_bf16 v[20:23], v[48:51], v[28:31], v[20:23]
s_waitcnt vmcnt(18)
v_mfma_f32_16x16x32_bf16 v[24:27], v[52:55], v[28:31], v[24:27]
v_and_b32 v28, v12, v6
v_and_b32 v29, v12, v7
v_and_b32 v30, v12, v8
v_and_b32 v31, v12, v9
s_waitcnt vmcnt(17)
s_nop 0
v_mfma_f32_16x16x32_bf16 v[16:19], v[56:59], v[28:31], v[16:19]
s_waitcnt vmcnt(16)
v_mfma_f32_16x16x32_bf16 v[20:23], v[60:63], v[28:31], v[20:23]
s_waitcnt vmcnt(15)
v_mfma_f32_16x16x32_bf16 v[24:27], v[64:67], v[28:31], v[24:27]
v_and_b32 v28, v13, v6
v_and_b32 v29, v13, v7
v_and_b32 v30, v13, v8
v_and_b32 v31, v13, v9
s_waitcnt vmcnt(14)
s_nop 0
v_mfma_f32_16x16x32_bf16 v[16:19], v[68:71], v[28:31], v[16:19]
s_waitcnt vmcnt(13)
v_mfma_f32_16x16x32_bf16 v[20:23], v[72:75], v[28:31], v[20:23]
s_waitcnt vmcnt(12)
v_mfma_f32_16x16x32_bf16 v[24:27], v[76:79], v[28:31], v[24:27]
ds_read_b128 v[10:13], v14 offset:2176
s_waitcnt lgkmcnt(0)
v_and_b32 v28, v10, v6
v_and_b32 v29, v10, v7
v_and_b32 v30, v10, v8
v_and_b32 v31, v10, v9
s_waitcnt vmcnt(11)
s_nop 0
v_mfma_f32_16x16x32_bf16 v[16:19], v[80:83], v[28:31], v[16:19]
s_waitcnt vmcnt(10)
v_mfma_f32_16x16x32_bf16 v[20:23], v[84:87], v[28:31], v[20:23]
s_waitcnt vmcnt(9)
v_mfma_f32_16x16x32_bf16 v[24:27], v[88:91], v[28:31], v[24:27]
v_and_b32 v28, v11, v6
v_and_b32 v29, v11, v7
v_and_b32 v30, v11, v8
v_and_b32 v31, v11, v9
s_waitcnt vmcnt(8)
s_nop 0
v_mfma_f32_16x16x32_bf16 v[16:19], v[92:95], v[28:31], v[16:19]
s_waitcnt vmcnt(7)
v_mfma_f32_16x16x32_bf16 v[20:23], v[96:99], v[28:31], v[20:23]
s_waitcnt vmcnt(6)
v_mfma_f32_16x16x32_bf16 v[24:27], v[100:103], v[28:31], v[24:27]
v_and_b32 v28, v12, v6
v_and_b32 v29, v12, v7
v_and_b32 v30, v12, v8
v_and_b32 v31, v12, v9
s_waitcnt vmcnt(5)
s_nop 0
v_mfma_f32_16x16x32_bf16 v[16:19], v[104:107], v[28:31], v[16:19]
s_waitcnt vmcnt(4)
v_mfma_f32_16x16x32_bf16 v[20:23], v[108:111], v[28:31], v[20:23]
s_waitcnt vmcnt(3)
v_mfma_f32_16x16x32_bf16 v[24:27], v[112:115], v[28:31], v[24:27]
v_and_b32 v28, v13, v6
v_and_b32 v29, v13, v7
v_and_b32 v30, v13, v8
v_and_b32 v31, v13, v9
s_waitcnt vmcnt(2)
s_nop 0
v_mfma_f32_16x16x32_bf16 v[16:19], v[116:119], v[28:31], v[16:19]
s_waitcnt vmcnt(1)
v_mfma_f32_16x16x32_bf16 v[20:23], v[120:123], v[28:31], v[20:23]
s_waitcnt vmcnt(0)
v_mfma_f32_16x16x32_bf16 v[24:27], v[124:127], v[28:31], v[24:27]
v_lshlrev_b32 v14, 4, v0
s_nop 2
v_permlane32_swap_b32 v16, v17
v_permlane32_swap_b32 v18, v19
v_permlane32_swap_b32 v20, v21
v_permlane32_swap_b32 v22, v23
v_permlane32_swap_b32 v24, v25
v_permlane32_swap_b32 v26, v27
v_add_f32_dpp v16, v17, v16 row_ror:8 row_mask:0xf bank_mask:0xf
v_add_f32_dpp v18, v19, v18 row_ror:8 row_mask:0xf bank_mask:0xf
v_add_f32_dpp v20, v21, v20 row_ror:8 row_mask:0xf bank_mask:0xf
v_add_f32_dpp v22, v23, v22 row_ror:8 row_mask:0xf bank_mask:0xf
v_add_f32_dpp v24, v25, v24 row_ror:8 row_mask:0xf bank_mask:0xf
v_add_f32_dpp v26, v27, v26 row_ror:8 row_mask:0xf bank_mask:0xf
s_and_b32 exec_lo, s3, 16711935
s_and_b32 exec_hi, s3, 16711935
ds_write_b32 v1, v16 offset:4096
ds_write_b32 v1, v18 offset:4160
ds_write_b32 v1, v20 offset:4352
ds_write_b32 v1, v22 offset:4416
ds_write_b32 v1, v24 offset:4608
ds_write_b32 v1, v26 offset:4672
s_and_b32 exec_lo, s3, 1
s_mov_b32 exec_hi, 0
ds_add_rtn_u32 v15, v3, v4 offset:20
s_mov_b32 exec_lo, s3
s_and_b32 exec_hi, s3, 65535
ds_read_b128 v[32:35], v14 offset:4096
ds_read_b128 v[36:39], v14 offset:4864
ds_read_b128 v[40:43], v14 offset:5632
ds_read_b128 v[44:47], v14 offset:6400
ds_read_b128 v[48:51], v14 offset:7168
ds_read_b128 v[52:55], v14 offset:7936
ds_read_b128 v[56:59], v14 offset:8704
ds_read_b128 v[60:63], v14 offset:9472
s_waitcnt lgkmcnt(8)
v_readfirstlane_b32 s62, v15
s_cbranch_execz L_VRED
s_cmp_lg_u32 s62, 7
s_cbranch_scc1 L_VEND
L_VRED:
s_waitcnt lgkmcnt(0)
v_pk_add_f32 v[32:33], v[32:33], v[36:37]
v_pk_add_f32 v[34:35], v[34:35], v[38:39]
v_pk_add_f32 v[40:41], v[40:41], v[44:45]
v_pk_add_f32 v[42:43], v[42:43], v[46:47]
v_pk_add_f32 v[48:49], v[48:49], v[52:53]
v_pk_add_f32 v[50:51], v[50:51], v[54:55]
v_pk_add_f32 v[56:57], v[56:57], v[60:61]
v_pk_add_f32 v[58:59], v[58:59], v[62:63]
v_pk_add_f32 v[32:33], v[32:33], v[40:41]
v_pk_add_f32 v[34:35], v[34:35], v[42:43]
v_pk_add_f32 v[48:49], v[48:49], v[56:57]
v_pk_add_f32 v[50:51], v[50:51], v[58:59]
v_pk_add_f32 v[32:33], v[32:33], v[48:49]
v_pk_add_f32 v[34:35], v[34:35], v[50:51]
v_or_b32 v32, 1, v32
v_or_b32 v33, 1, v33
v_or_b32 v34, 1, v34
v_or_b32 v35, 1, v35
s_cmp_eq_u32 s73, 1
s_cbranch_scc1 LS_54
buffer_store_dwordx4 v[32:35], v14, s[52:55], s72 offen sc1
s_branch LSE_55
LS_54:
buffer_store_dwordx4 v[32:35], v14, s[52:55], s72 offen
LSE_55:
ds_write_b32 v3, v4 offset:24
s_cbranch_execz L_DRYRET
L_VEND:
s_endpgm
L_KWAVE:
buffer_load_dwordx4 v[32:35], v2, s[8:11], s65 offen offset:0 nt
s_barrier
s_mov_b32 s63, 0
s_cbranch_execz LWD_57
LW_56:
ds_read_b32 v6, v3 offset:48
s_waitcnt lgkmcnt(0)
v_readfirstlane_b32 s62, v6
s_nop 0
s_cmp_ge_u32 s62, 2
s_cbranch_scc1 LWD_57
s_sleep 1
s_add_u32 s63, s63, 1
s_cmp_lt_u32 s63, 2400000
s_cbranch_scc1 LW_56
LWD_57:
buffer_load_dwordx4 v[36:39], v2, s[8:11], s65 offen offset:128 nt
buffer_load_dwordx4 v[40:43], v2, s[8:11], s65 offen offset:256 nt
s_waitcnt vmcnt(2)
buffer_load_dwordx4 v[44:47], v2, s[8:11], s65 offen offset:384 nt
s_waitcnt vmcnt(2)
buffer_load_dwordx4 v[48:51], v2, s[8:11], s65 offen offset:512 nt
s_waitcnt vmcnt(2)
buffer_load_dwordx4 v[52:55], v2, s[8:11], s65 offen offset:640 nt
s_waitcnt vmcnt(2)
buffer_load_dwordx4 v[56:59], v2, s[8:11], s65 offen offset:768 nt
s_waitcnt vmcnt(2)
buffer_load_dwordx4 v[60:63], v2, s[8:11], s65 offen offset:896 nt
s_waitcnt vmcnt(2)
buffer_load_dwordx4 v[64:67], v2, s[8:11], s65 offen offset:1024 nt
s_waitcnt vmcnt(2)
buffer_load_dwordx4 v[68:71], v2, s[8:11], s65 offen offset:1152 nt
s_waitcnt vmcnt(2)
buffer_load_dwordx4 v[72:75], v2, s[8:11], s65 offen offset:1280 nt
s_waitcnt vmcnt(2)
buffer_load_dwordx4 v[76:79], v2, s[8:11], s65 offen offset:1408 nt
ds_read_b32 v6, v3 offset:8
s_waitcnt vmcnt(2) lgkmcnt(0)
v_readfirstlane_b32 s62, v6
s_nop 0
s_cmp_lg_u32 s62, 0
s_cbranch_scc1 L_KF_12
buffer_load_dwordx4 v[80:83], v2, s[8:11], s66 offen offset:0 nt
ds_read_b32 v6, v3 offset:8
s_waitcnt vmcnt(2) lgkmcnt(0)
v_readfirstlane_b32 s62, v6
s_nop 0
s_cmp_lg_u32 s62, 0
s_cbranch_scc1 L_KF_13
buffer_load_dwordx4 v[84:87], v2, s[8:11], s66 offen offset:128 nt
ds_read_b32 v6, v3 offset:8
s_waitcnt vmcnt(2) lgkmcnt(0)
v_readfirstlane_b32 s62, v6
s_nop 0
s_cmp_lg_u32 s62, 0
s_cbranch_scc1 L_KF_14
buffer_load_dwordx4 v[88:91], v2, s[8:11], s66 offen offset:256 nt
ds_read_b32 v6, v3 offset:8
s_waitcnt vmcnt(2) lgkmcnt(0)
v_readfirstlane_b32 s62, v6
s_nop 0
s_cmp_lg_u32 s62, 0
s_cbranch_scc1 L_KF_15
buffer_load_dwordx4 v[92:95], v2, s[8:11], s66 offen offset:384 nt
ds_read_b32 v6, v3 offset:8
s_waitcnt vmcnt(2) lgkmcnt(0)
v_readfirstlane_b32 s62, v6
s_nop 0
s_cmp_lg_u32 s62, 0
s_cbranch_scc1 L_KF_16
buffer_load_dwordx4 v[96:99], v2, s[8:11], s66 offen offset:512 nt
ds_read_b32 v6, v3 offset:8
s_waitcnt vmcnt(2) lgkmcnt(0)
v_readfirstlane_b32 s62, v6
s_nop 0
s_cmp_lg_u32 s62, 0
s_cbranch_scc1 L_KF_17
buffer_load_dwordx4 v[100:103], v2, s[8:11], s66 offen offset:640 nt
ds_read_b32 v6, v3 offset:8
s_waitcnt vmcnt(2) lgkmcnt(0)
v_readfirstlane_b32 s62, v6
s_nop 0
s_cmp_lg_u32 s62, 0
s_cbranch_scc1 L_KF_18
buffer_load_dwordx4 v[104:107], v2, s[8:11], s66 offen offset:768 nt
ds_read_b32 v6, v3 offset:8
s_waitcnt vmcnt(2) lgkmcnt(0)
v_readfirstlane_b32 s62, v6
s_nop 0
s_cmp_lg_u32 s62, 0
s_cbranch_scc1 L_KF_19
buffer_load_dwordx4 v[108:111], v2, s[8:11], s66 offen offset:896 nt
ds_read_b32 v6, v3 offset:8
s_waitcnt vmcnt(2) lgkmcnt(0)
v_readfirstlane_b32 s62, v6
s_nop 0
s_cmp_lg_u32 s62, 0
s_cbranch_scc1 L_KF_20
buffer_load_dwordx4 v[112:115], v2, s[8:11], s66 offen offset:1024 nt
ds_read_b32 v6, v3 offset:8
s_waitcnt vmcnt(2) lgkmcnt(0)
v_readfirstlane_b32 s62, v6
s_nop 0
s_cmp_lg_u32 s62, 0
s_cbranch_scc1 L_KF_21
buffer_load_dwordx4 v[116:119], v2, s[8:11], s66 offen offset:1152 nt
ds_read_b32 v6, v3 offset:8
s_waitcnt vmcnt(2) lgkmcnt(0)
v_readfirstlane_b32 s62, v6
s_nop 0
s_cmp_lg_u32 s62, 0
s_cbranch_scc1 L_KF_22
buffer_load_dwordx4 v[120:123], v2, s[8:11], s66 offen offset:1280 nt
ds_read_b32 v6, v3 offset:8
s_waitcnt vmcnt(2) lgkmcnt(0)
v_readfirstlane_b32 s62, v6
s_nop 0
s_cmp_lg_u32 s62, 0
s_cbranch_scc1 L_KF_23
buffer_load_dwordx4 v[124:127], v2, s[8:11], s66 offen offset:1408 nt
s_branch L_KF_E
L_KF_12:
buffer_load_dwordx4 v[80:83], v2, s[8:11], s66 offen offset:0 nt
L_KF_13:
buffer_load_dwordx4 v[84:87], v2, s[8:11], s66 offen offset:128 nt
L_KF_14:
buffer_load_dwordx4 v[88:91], v2, s[8:11], s66 offen offset:256 nt
L_KF_15:
buffer_load_dwordx4 v[92:95], v2, s[8:11], s66 offen offset:384 nt
L_KF_16:
buffer_load_dwordx4 v[96:99], v2, s[8:11], s66 offen offset:512 nt
L_KF_17:
buffer_load_dwordx4 v[100:103], v2, s[8:11], s66 offen offset:640 nt
L_KF_18:
buffer_load_dwordx4 v[104:107], v2, s[8:11], s66 offen offset:768 nt
L_KF_19:
buffer_load_dwordx4 v[108:111], v2, s[8:11], s66 offen offset:896 nt
L_KF_20:
buffer_load_dwordx4 v[112:115], v2, s[8:11], s66 offen offset:1024 nt
L_KF_21:
buffer_load_dwordx4 v[116:119], v2, s[8:11], s66 offen offset:1152 nt
L_KF_22:
buffer_load_dwordx4 v[120:123], v2, s[8:11], s66 offen offset:1280 nt
L_KF_23:
buffer_load_dwordx4 v[124:127], v2, s[8:11], s66 offen offset:1408 nt
L_KF_E:
ds_write_b32 v5, v4 offset:64
L_K_DRY:
v_and_b32 v6, 7, v0
v_lshlrev_b32 v6, 4, v6
s_lshl_b32 s62, s59, 6
s_lshl_b32 s63, s60, 3
s_add_u32 s62, s62, s63
s_add_u32 s62, s62, s61
s_lshl_b32 s62, s62, 3
s_add_u32 s72, s62, 393216
s_mov_b32 s80, 4042322160
s_mov_b32 s81, 4042322160
s_mov_b32 s82, 2863311530
s_mov_b32 s83, 2863311530
s_mov_b32 s84, 3435973836
s_mov_b32 s85, 3435973836
s_mov_b32 s63, 0
s_cbranch_execz LWD_59
LW_58:
ds_read_b32 v7, v3 offset:60
s_waitcnt lgkmcnt(0)
v_readfirstlane_b32 s62, v7
s_nop 0
s_cmp_lg_u32 s62, 0
s_cbranch_scc1 LWD_59
s_sleep 1
s_add_u32 s63, s63, 1
s_cmp_lt_u32 s63, 2400000
s_cbranch_scc1 LW_58
LWD_59:
s_mov_b32 s73, s62
s_mov_b32 s63, 0
s_cbranch_execz LWD_61
LW_60:
ds_read_b32 v7, v3 offset:8
s_waitcnt lgkmcnt(0)
v_readfirstlane_b32 s62, v7
s_nop 0
s_cmp_lg_u32 s62, 0
s_cbranch_scc1 LWD_61
s_sleep 1
s_add_u32 s63, s63, 1
s_cmp_lt_u32 s63, 2400000
s_cbranch_scc1 LW_60
LWD_61:
ds_read_b128 v[8:11], v6 offset:896
ds_read_b128 v[12:15], v6 offset:1024
ds_read_b128 v[16:19], v6 offset:1152
s_waitcnt lgkmcnt(0)
s_waitcnt vmcnt(18)
v_dot2_f32_bf16 v20, v32, v8, 0
v_dot2_f32_bf16 v21, v44, v8, 0
v_dot2_f32_bf16 v20, v33, v9, v20
v_dot2_f32_bf16 v21, v45, v9, v21
v_dot2_f32_bf16 v20, v34, v10, v20
v_dot2_f32_bf16 v21, v46, v10, v21
v_dot2_f32_bf16 v20, v35, v11, v20
v_dot2_f32_bf16 v21, v47, v11, v21
v_dot2_f32_bf16 v20, v36, v12, v20
v_dot2_f32_bf16 v21, v48, v12, v21
v_dot2_f32_bf16 v20, v37, v13, v20
v_dot2_f32_bf16 v21, v49, v13, v21
v_dot2_f32_bf16 v20, v38, v14, v20
v_dot2_f32_bf16 v21, v50, v14, v21
v_dot2_f32_bf16 v20, v39, v15, v20
v_dot2_f32_bf16 v21, v51, v15, v21
v_dot2_f32_bf16 v20, v40, v16, v20
v_dot2_f32_bf16 v21, v52, v16, v21
v_dot2_f32_bf16 v20, v41, v17, v20
v_dot2_f32_bf16 v21, v53, v17, v21
v_dot2_f32_bf16 v20, v42, v18, v20
v_dot2_f32_bf16 v21, v54, v18, v21
v_dot2_f32_bf16 v20, v43, v19, v20
v_dot2_f32_bf16 v21, v55, v19, v21
s_waitcnt vmcnt(12)
v_dot2_f32_bf16 v22, v56, v8, 0
v_dot2_f32_bf16 v23, v68, v8, 0
v_dot2_f32_bf16 v22, v57, v9, v22
v_dot2_f32_bf16 v23, v69, v9, v23
v_dot2_f32_bf16 v22, v58, v10, v22
v_dot2_f32_bf16 v23, v70, v10, v23
v_dot2_f32_bf16 v22, v59, v11, v22
v_dot2_f32_bf16 v23, v71, v11, v23
v_dot2_f32_bf16 v22, v60, v12, v22
v_dot2_f32_bf16 v23, v72, v12, v23
v_dot2_f32_bf16 v22, v61, v13, v22
v_dot2_f32_bf16 v23, v73, v13, v23
v_dot2_f32_bf16 v22, v62, v14, v22
v_dot2_f32_bf16 v23, v74, v14, v23
v_dot2_f32_bf16 v22, v63, v15, v22
v_dot2_f32_bf16 v23, v75, v15, v23
v_dot2_f32_bf16 v22, v64, v16, v22
v_dot2_f32_bf16 v23, v76, v16, v23
v_dot2_f32_bf16 v22, v65, v17, v22
v_dot2_f32_bf16 v23, v77, v17, v23
v_dot2_f32_bf16 v22, v66, v18, v22
v_dot2_f32_bf16 v23, v78, v18, v23
v_dot2_f32_bf16 v22, v67, v19, v22
v_dot2_f32_bf16 v23, v79, v19, v23
s_waitcnt vmcnt(6)
v_dot2_f32_bf16 v24, v80, v8, 0
v_dot2_f32_bf16 v25, v92, v8, 0
v_dot2_f32_bf16 v24, v81, v9, v24
v_dot2_f32_bf16 v25, v93, v9, v25
v_dot2_f32_bf16 v24, v82, v10, v24
v_dot2_f32_bf16 v25, v94, v10, v25
v_dot2_f32_bf16 v24, v83, v11, v24
v_dot2_f32_bf16 v25, v95, v11, v25
v_dot2_f32_bf16 v24, v84, v12, v24
v_dot2_f32_bf16 v25, v96, v12, v25
v_dot2_f32_bf16 v24, v85, v13, v24
v_dot2_f32_bf16 v25, v97, v13, v25
v_dot2_f32_bf16 v24, v86, v14, v24
v_dot2_f32_bf16 v25, v98, v14, v25
v_dot2_f32_bf16 v24, v87, v15, v24
v_dot2_f32_bf16 v25, v99, v15, v25
v_dot2_f32_bf16 v24, v88, v16, v24
v_dot2_f32_bf16 v25, v100, v16, v25
v_dot2_f32_bf16 v24, v89, v17, v24
v_dot2_f32_bf16 v25, v101, v17, v25
v_dot2_f32_bf16 v24, v90, v18, v24
v_dot2_f32_bf16 v25, v102, v18, v25
v_dot2_f32_bf16 v24, v91, v19, v24
v_dot2_f32_bf16 v25, v103, v19, v25
s_waitcnt vmcnt(0)
v_dot2_f32_bf16 v26, v104, v8, 0
v_dot2_f32_bf16 v27, v116, v8, 0
v_dot2_f32_bf16 v26, v105, v9, v26
v_dot2_f32_bf16 v27, v117, v9, v27
v_dot2_f32_bf16 v26, v106, v10, v26
v_dot2_f32_bf16 v27, v118, v10, v27
v_dot2_f32_bf16 v26, v107, v11, v26
v_dot2_f32_bf16 v27, v119, v11, v27
v_dot2_f32_bf16 v26, v108, v12, v26
v_dot2_f32_bf16 v27, v120, v12, v27
v_dot2_f32_bf16 v26, v109, v13, v26
v_dot2_f32_bf16 v27, v121, v13, v27
v_dot2_f32_bf16 v26, v110, v14, v26
v_dot2_f32_bf16 v27, v122, v14, v27
v_dot2_f32_bf16 v26, v111, v15, v26
v_dot2_f32_bf16 v27, v123, v15, v27
v_dot2_f32_bf16 v26, v112, v16, v26
v_dot2_f32_bf16 v27, v124, v16, v27
v_dot2_f32_bf16 v26, v113, v17, v26
v_dot2_f32_bf16 v27, v125, v17, v27
v_dot2_f32_bf16 v26, v114, v18, v26
v_dot2_f32_bf16 v27, v126, v18, v27
v_dot2_f32_bf16 v26, v115, v19, v26
v_dot2_f32_bf16 v27, v127, v19, v27
v_cndmask_b32 v8, v20, v24, s[80:81]
v_cndmask_b32 v12, v24, v20, s[80:81]
v_cndmask_b32 v9, v21, v25, s[80:81]
v_cndmask_b32 v13, v25, v21, s[80:81]
v_cndmask_b32 v10, v22, v26, s[80:81]
v_cndmask_b32 v14, v26, v22, s[80:81]
v_cndmask_b32 v11, v23, v27, s[80:81]
v_cndmask_b32 v15, v27, v23, s[80:81]
v_add_f32_dpp v8, v12, v8 row_half_mirror row_mask:0xf bank_mask:0xf
v_add_f32_dpp v9, v13, v9 row_half_mirror row_mask:0xf bank_mask:0xf
v_add_f32_dpp v10, v14, v10 row_half_mirror row_mask:0xf bank_mask:0xf
v_add_f32_dpp v11, v15, v11 row_half_mirror row_mask:0xf bank_mask:0xf
v_cndmask_b32 v12, v8, v9, s[82:83]
v_cndmask_b32 v14, v9, v8, s[82:83]
v_cndmask_b32 v13, v10, v11, s[82:83]
v_cndmask_b32 v15, v11, v10, s[82:83]
v_add_f32_dpp v12, v14, v12 quad_perm:[1,0,3,2] row_mask:0xf bank_mask:0xf
s_nop 0
v_add_f32_dpp v13, v15, v13 quad_perm:[1,0,3,2] row_mask:0xf bank_mask:0xf
v_cndmask_b32 v8, v12, v13, s[84:85]
v_cndmask_b32 v9, v13, v12, s[84:85]
s_nop 1
v_add_f32_dpp v8, v9, v8 quad_perm:[2,3,0,1] row_mask:0xf bank_mask:0xf
v_cvt_pk_bf16_f32 v8, v8, v8
v_and_b32 v8, 0xffff0000, v8
v_mul_f32 v8, 1033096506, v8
v_cvt_pk_bf16_f32 v8, v8, v8
v_and_b32 v8, 0xffff0000, v8
v_mov_b32 v9, v8
s_nop 1
v_max_f32_dpp v9, v9, v9 quad_perm:[1,0,3,2] row_mask:0xf bank_mask:0xf
s_nop 1
v_max_f32_dpp v9, v9, v9 quad_perm:[2,3,0,1] row_mask:0xf bank_mask:0xf
s_nop 1
v_max_f32_dpp v9, v9, v9 row_half_mirror row_mask:0xf bank_mask:0xf
s_nop 1
v_max_f32_dpp v9, v9, v9 row_mirror row_mask:0xf bank_mask:0xf
v_mov_b32 v10, v9
s_nop 1
v_permlane16_swap_b32 v9, v10
v_max_f32 v9, v9, v10
v_mov_b32 v10, v9
s_nop 1
v_permlane32_swap_b32 v9, v10
v_max_f32 v9, v9, v10
v_sub_f32 v10, v8, v9
v_mul_f32 v10, 1069066811, v10
v_exp_f32 v10, v10
s_nop 1
v_add_f32_dpp v10, v10, v10 quad_perm:[1,0,3,2] row_mask:0xf bank_mask:0xf
s_nop 1
v_add_f32_dpp v10, v10, v10 quad_perm:[2,3,0,1] row_mask:0xf bank_mask:0xf
s_nop 1
v_add_f32_dpp v10, v10, v10 row_half_mirror row_mask:0xf bank_mask:0xf
s_nop 1
v_add_f32_dpp v10, v10, v10 row_mirror row_mask:0xf bank_mask:0xf
v_mov_b32 v11, v10
s_nop 1
v_permlane16_swap_b32 v10, v11
v_add_f32 v10, v10, v11
v_mov_b32 v11, v10
s_nop 1
v_permlane32_swap_b32 v10, v11
v_add_f32 v10, v10, v11
v_or_b32 v12, 1, v9
v_mov_b32 v13, v10
s_and_b32 exec_lo, s3, 1
s_mov_b32 exec_hi, 0
s_cmp_eq_u32 s73, 1
s_cbranch_scc1 LS_62
buffer_store_dwordx2 v[12:13], v3, s[52:55], s72 offen sc1
s_branch LSE_63
LS_62:
buffer_store_dwordx2 v[12:13], v3, s[52:55], s72 offen
LSE_63:
s_mov_b32 exec_lo, s3
s_mov_b32 exec_hi, s3
v_mov_b32 v127, v8
s_cmp_lt_u32 s61, 2
s_cselect_b32 s62, 8, 0
v_add_u32 v126, s62, v5
s_cmp_lt_u32 s58, 20
s_cbranch_scc1 L_TW
s_cmp_lt_u32 s57, 4
s_cbranch_scc1 L_TG
s_cmp_lt_u32 s58, 30
s_cbranch_scc1 NR_64
s_cmp_ge_u32 s57, 4
s_cbranch_scc1 L_TNONE
NR_64:
s_branch L_TD
L_TNONE:
s_mov_b32 s63, 0
s_cbranch_execz LWD_66
LW_65:
ds_read_b32 v120, v3 offset:12
s_waitcnt lgkmcnt(0)
v_readfirstlane_b32 s62, v120
s_nop 0
s_cmp_lg_u32 s62, 0
s_cbranch_scc1 LWD_66
s_sleep 1
s_add_u32 s63, s63, 1
s_cmp_lt_u32 s63, 2400000
s_cbranch_scc1 LW_65
LWD_66:
ds_read_b64 v[120:121], v3 offset:192
v_bfe_u32 v122, v0, 2, 1
v_lshlrev_b32 v122, 5, v122
v_lshrrev_b32 v123, 3, v0
v_lshl_add_u32 v122, v123, 2, v122
v_and_b32 v123, 3, v0
v_add_u32 v122, v122, v123
v_lshlrev_b32 v122, 2, v122
s_lshl_b32 s62, s61, 8
v_add_u32 v122, s62, v122
s_waitcnt lgkmcnt(0)
v_sub_f32 v127, v127, v120
v_mul_f32 v127, 1069066811, v127
v_exp_f32 v127, v127
v_rcp_f32 v120, v121
s_nop 0
v_mul_f32 v123, v127, v120
v_fma_f32 v124, -v123, v121, v127
v_fma_f32 v125, v124, v120, v123
v_cmp_o_f32 vcc, v125, v125
s_nop 1
v_cndmask_b32 v127, v123, v125, vcc
v_cvt_pk_bf16_f32 v127, v127, v127
ds_write_b32 v122, v127 offset:2048
ds_write_b32 v5, v4 offset:128
s_branch L_KEND
L_TW:
s_and_b32 s76, s61, 3
s_lshr_b32 s77, s61, 2
s_mul_i32 s78, s76, 12288
s_add_u32 s78, s78, 77824
v_lshrrev_b32 v12, 2, v0
v_lshlrev_b32 v12, 7, v12
v_and_b32 v13, 3, v0
v_lshl_add_u32 v12, v13, 3, v12
v_add_u32 v12, s78, v12
v_bfe_u32 v13, v0, 3, 2
s_lshl_b32 s62, s77, 1
v_xor_b32 v10, s62, v13
v_xor_b32 v11, 1, v10
v_lshl_add_u32 v10, v10, 5, v12
v_lshl_add_u32 v11, v11, 5, v12
s_lshl_b32 s74, s61, 9
s_add_u32 s74, s74, 8192
v_lshrrev_b32 v19, 4, v0
v_lshl_add_u32 v19, v19, 3, s74
v_lshrrev_b32 v18, 4, v0
v_lshlrev_b32 v18, 4, v18
s_lshl_b32 s62, s76, 8
s_lshl_b32 s63, s77, 7
s_add_u32 s62, s62, s63
v_add_u32 v18, s62, v18
v_lshlrev_b32 v27, 3, v0
s_mul_i32 s62, s77, 6144
s_add_u32 s73, s78, s62
v_lshrrev_b32 v7, 3, v0
v_and_b32 v8, 7, v0
v_bfe_u32 v6, v7, 1, 2
v_lshlrev_b32 v6, 1, v6
v_xor_b32 v8, v8, v6
v_mul_u32_u24 v7, 1280, v7
v_lshl_add_u32 v6, v8, 4, v7
s_and_b32 s75, s58, 1
s_mul_i32 s70, s57, 768
s_mul_i32 s62, s75, 384
s_add_u32 s70, s70, s62
s_mul_i32 s62, s76, 96
s_add_u32 s70, s70, s62
s_lshl_b32 s62, s57, 2
s_lshl_b32 s63, s75, 1
s_add_u32 s62, s62, s63
s_lshr_b32 s63, s76, 1
s_add_u32 s62, s62, s63
s_mul_i32 s62, s62, 6144
s_and_b32 s63, s76, 1
s_mul_i32 s63, s63, 384
s_add_u32 s62, s62, s63
v_lshrrev_b32 v14, 5, v0
v_mul_u32_u24 v14, 3072, v14
v_and_b32 v15, 31, v0
v_lshl_add_u32 v14, v15, 4, v14
v_add_u32 v14, s62, v14
s_mul_i32 s62, s77, 48
s_add_u32 s70, s70, s62
s_mul_i32 s70, s70, 1280
s_lshr_b32 s62, s58, 1
s_lshl_b32 s62, s62, 7
s_add_u32 s70, s70, s62
v_lshl_add_u32 v16, v15, 3, s74
s_lshl_b32 s63, s57, 1
s_add_u32 s63, s63, s75
s_mul_i32 s75, s63, 2560
s_lshl_b32 s62, s62, 1
s_add_u32 s75, s75, s62
s_add_u32 s75, s75, 0
s_mov_b32 s63, 0
s_cbranch_execz LWD_68
LW_67:
ds_read_b32 v120, v3 offset:12
s_waitcnt lgkmcnt(0)
v_readfirstlane_b32 s62, v120
s_nop 0
s_cmp_lg_u32 s62, 0
s_cbranch_scc1 LWD_68
s_sleep 1
s_add_u32 s63, s63, 1
s_cmp_lt_u32 s63, 2400000
s_cbranch_scc1 LW_67
LWD_68:
ds_read_b64 v[120:121], v3 offset:192
v_bfe_u32 v122, v0, 2, 1
v_lshlrev_b32 v122, 5, v122
v_lshrrev_b32 v123, 3, v0
v_lshl_add_u32 v122, v123, 2, v122
v_and_b32 v123, 3, v0
v_add_u32 v122, v122, v123
v_lshlrev_b32 v122, 2, v122
s_lshl_b32 s62, s61, 8
v_add_u32 v122, s62, v122
s_waitcnt lgkmcnt(0)
v_sub_f32 v127, v127, v120
v_mul_f32 v127, 1069066811, v127
v_exp_f32 v127, v127
v_rcp_f32 v120, v121
s_nop 0
v_mul_f32 v123, v127, v120
v_fma_f32 v124, -v123, v121, v127
v_fma_f32 v125, v124, v120, v123
v_cmp_o_f32 vcc, v125, v125
s_nop 1
v_cndmask_b32 v127, v123, v125, vcc
v_cvt_pk_bf16_f32 v127, v127, v127
ds_write_b32 v122, v127 offset:2048
ds_write_b32 v5, v4 offset:128
s_mov_b32 s63, 0
s_cbranch_execz LWD_70
LW_69:
ds_read_b32 v7, v3 offset:96
s_waitcnt lgkmcnt(0)
v_readfirstlane_b32 s62, v7
s_nop 0
s_cmp_ge_u32 s62, 6
s_cbranch_scc1 LWD_70
s_sleep 1
s_add_u32 s63, s63, 1
s_cmp_lt_u32 s63, 2400000
s_cbranch_scc1 LW_69
LWD_70:
s_cbranch_execz DS_71
s_add_u32 m0, s73, 0
s_nop 0
buffer_load_dwordx4 v6, s[20:23], s70 offen nt lds
s_add_u32 s70, s70, 10240
s_add_u32 m0, s73, 1024
s_nop 0
buffer_load_dwordx4 v6, s[20:23], s70 offen nt lds
s_add_u32 s70, s70, 10240
s_add_u32 m0, s73, 2048
s_nop 0
buffer_load_dwordx4 v6, s[20:23], s70 offen nt lds
s_add_u32 s70, s70, 10240
s_waitcnt vmcnt(2)
s_add_u32 m0, s73, 3072
s_nop 0
buffer_load_dwordx4 v6, s[20:23], s70 offen nt lds
s_add_u32 s70, s70, 10240
s_waitcnt vmcnt(2)
s_add_u32 m0, s73, 4096
s_nop 0
buffer_load_dwordx4 v6, s[20:23], s70 offen nt lds
s_add_u32 s70, s70, 10240
s_waitcnt vmcnt(2)
s_add_u32 m0, s73, 5120
s_nop 0
buffer_load_dwordx4 v6, s[20:23], s70 offen nt lds
DS_71:
v_mov_b32 v112, 0
v_mov_b32 v113, 0
v_mov_b32 v114, 0
v_mov_b32 v115, 0
v_mov_b32 v116, 0
v_mov_b32 v117, 0
v_mov_b32 v118, 0
v_mov_b32 v119, 0
s_waitcnt vmcnt(0)
s_and_b32 exec_lo, s3, 1
s_mov_b32 exec_hi, 0
ds_add_u32 v3, v4 offset:40
s_mov_b32 exec_lo, s3
s_mov_b32 exec_hi, s3
s_mov_b32 s63, 0
s_cbranch_execz LWD_73
LW_72:
ds_read_b32 v7, v3 offset:40
s_waitcnt lgkmcnt(0)
v_readfirstlane_b32 s62, v7
s_nop 0
s_cmp_ge_u32 s62, 8
s_cbranch_scc1 LWD_73
s_sleep 1
s_add_u32 s63, s63, 1
s_cmp_lt_u32 s63, 2400000
s_cbranch_scc1 LW_72
LWD_73:
ds_read_b64_tr_b16 v[64:65], v10 offset:0
ds_read_b64_tr_b16 v[66:67], v10 offset:2048
ds_read_b64_tr_b16 v[68:69], v11 offset:0
ds_read_b64_tr_b16 v[70:71], v11 offset:2048
ds_read_b64_tr_b16 v[72:73], v10 offset:4096
ds_read_b64_tr_b16 v[74:75], v10 offset:6144
ds_read_b64_tr_b16 v[76:77], v11 offset:4096
ds_read_b64_tr_b16 v[78:79], v11 offset:6144
ds_read_b64_tr_b16 v[80:81], v10 offset:8192
ds_read_b64_tr_b16 v[82:83], v10 offset:10240
ds_read_b64_tr_b16 v[84:85], v11 offset:8192
ds_read_b64_tr_b16 v[86:87], v11 offset:10240
s_mov_b32 s63, 0
s_cbranch_execz LWD_75
LW_74:
ds_read_b32 v7, v3 offset:24
s_waitcnt lgkmcnt(0)
v_readfirstlane_b32 s62, v7
s_nop 0
s_cmp_lg_u32 s62, 0
s_cbranch_scc1 LWD_75
s_sleep 1
s_add_u32 s63, s63, 1
s_cmp_lt_u32 s63, 2400000
s_cbranch_scc1 LW_74
LWD_75:
s_and_b32 exec_lo, s3, 16777215
s_and_b32 exec_hi, s3, 16777215
s_mov_b32 s63, 0
s_mov_b32 s64, 458752
PL_76:
buffer_load_dwordx4 v[32:35], v14, s[52:55], s64 offen offset:0 sc1
buffer_load_dwordx4 v[36:39], v14, s[52:55], s64 offen offset:768 sc1
buffer_load_dwordx4 v[40:43], v14, s[52:55], s64 offen offset:1536 sc1
buffer_load_dwordx4 v[44:47], v14, s[52:55], s64 offen offset:2304 sc1
s_waitcnt vmcnt(0)
v_min3_u32 v7, v32, v33, v34
v_min3_u32 v7, v7, v35, v36
v_min3_u32 v7, v7, v37, v38
v_min3_u32 v7, v7, v39, v40
v_min3_u32 v7, v7, v41, v42
v_min3_u32 v7, v7, v43, v44
v_min3_u32 v7, v7, v45, v46
v_min_u32 v7, v7, v47
v_cmp_eq_u32 vcc, 0, v7
s_cbranch_vccz PD_77
s_add_u32 s63, s63, 1
s_cmp_lt_u32 s63, 300000
s_cbranch_scc1 PL_76
PD_77:
v_pk_add_f32 v[32:33], v[32:33], v[36:37]
v_pk_add_f32 v[34:35], v[34:35], v[38:39]
v_pk_add_f32 v[40:41], v[40:41], v[44:45]
v_pk_add_f32 v[42:43], v[42:43], v[46:47]
v_pk_add_f32 v[32:33], v[32:33], v[40:41]
v_pk_add_f32 v[34:35], v[34:35], v[42:43]
v_mov_b32 v36, v32
v_mov_b32 v37, v33
v_mov_b32 v38, v34
v_mov_b32 v39, v35
v_permlane32_swap_b32 v32, v36
v_permlane32_swap_b32 v33, v37
v_permlane32_swap_b32 v34, v38
v_permlane32_swap_b32 v35, v39
v_pk_add_f32 v[32:33], v[32:33], v[36:37]
v_pk_add_f32 v[34:35], v[34:35], v[38:39]
v_cvt_pk_bf16_f32 v36, v32, v33
v_cvt_pk_bf16_f32 v37, v34, v35
ds_write_b64 v16, v[36:37]
s_mov_b32 exec_lo, s3
s_mov_b32 exec_hi, s3
ds_read2_b64 v[40:43], v19 offset0:0 offset1:4
ds_read2_b64 v[44:47], v19 offset0:8 offset1:12
ds_read2_b64 v[48:51], v19 offset0:16 offset1:20
s_waitcnt lgkmcnt(2)
v_mfma_f32_16x16x32_bf16 v[112:115], v[64:67], v[40:43], v[112:115]
v_mfma_f32_16x16x32_bf16 v[116:119], v[68:71], v[40:43], v[116:119]
s_waitcnt lgkmcnt(1)
v_mfma_f32_16x16x32_bf16 v[112:115], v[72:75], v[44:47], v[112:115]
v_mfma_f32_16x16x32_bf16 v[116:119], v[76:79], v[44:47], v[116:119]
s_waitcnt lgkmcnt(0)
v_mfma_f32_16x16x32_bf16 v[112:115], v[80:83], v[48:51], v[112:115]
v_mfma_f32_16x16x32_bf16 v[116:119], v[84:87], v[48:51], v[116:119]
s_and_b32 exec_lo, s3, 65537
s_and_b32 exec_hi, s3, 65537
s_nop 4
ds_write_b128 v18, v[112:115] offset:6656
ds_write_b128 v18, v[116:119] offset:6720
s_waitcnt lgkmcnt(0)
s_cbranch_execz BR_78
s_barrier
BR_78:
s_cmp_lg_u32 s61, 0
s_cbranch_scc1 L_KEND
s_mov_b32 exec_lo, s3
s_mov_b32 exec_hi, 0
ds_read_b64 v[32:33], v27 offset:6656
ds_read_b64 v[34:35], v27 offset:6912
ds_read_b64 v[36:37], v27 offset:7168
ds_read_b64 v[38:39], v27 offset:7424
s_waitcnt lgkmcnt(0)
v_pk_add_f32 v[32:33], v[32:33], v[34:35]
v_pk_add_f32 v[36:37], v[36:37], v[38:39]
v_pk_add_f32 v[32:33], v[32:33], v[36:37]
v_or_b32 v32, 1, v32
v_or_b32 v33, 1, v33
s_nop 0
v_mov_b32_dpp v34, v32 quad_perm:[1,1,3,3] row_mask:0xf bank_mask:0xf
v_mov_b32_dpp v35, v33 quad_perm:[1,1,3,3] row_mask:0xf bank_mask:0xf
s_and_b32 exec_lo, s3, 1431655765
s_mov_b32 exec_hi, 0
buffer_store_dwordx4 v[32:35], v27, s[52:55], s75 offen sc1
s_branch L_KEND
L_TG:
s_mul_i32 s75, s57, 12
s_add_u32 s75, s75, s58
s_sub_u32 s75, s75, 20
s_and_b32 s76, s61, 3
s_lshr_b32 s77, s61, 2
s_mul_i32 s78, s76, 20480
s_add_u32 s78, s78, 77824
v_lshrrev_b32 v12, 2, v0
v_lshlrev_b32 v12, 7, v12
v_and_b32 v13, 3, v0
v_lshl_add_u32 v12, v13, 3, v12
v_add_u32 v12, s78, v12
v_bfe_u32 v13, v0, 3, 2
s_lshl_b32 s62, s77, 1
v_xor_b32 v10, s62, v13
v_xor_b32 v11, 1, v10
v_lshl_add_u32 v10, v10, 5, v12
v_lshl_add_u32 v11, v11, 5, v12
s_lshl_b32 s74, s61, 9
s_add_u32 s74, s74, 8192
v_lshrrev_b32 v19, 4, v0
v_lshl_add_u32 v19, v19, 3, s74
v_lshrrev_b32 v18, 4, v0
v_lshlrev_b32 v18, 4, v18
s_lshl_b32 s62, s76, 8
s_lshl_b32 s63, s77, 7
s_add_u32 s62, s62, s63
v_add_u32 v18, s62, v18
v_lshlrev_b32 v27, 3, v0
s_mul_i32 s62, s77, 10240
s_add_u32 s73, s78, s62
s_bitcmp1_b32 s75, 0
s_cselect_b32 s68, s28, s24
s_cselect_b32 s69, s29, s25
s_mov_b32 s70, 1966080
s_mov_b32 s71, 0x20000
v_lshrrev_b32 v7, 3, v0
v_and_b32 v8, 7, v0
v_bfe_u32 v6, v7, 1, 2
v_lshlrev_b32 v6, 1, v6
v_xor_b32 v8, v8, v6
v_mul_u32_u24 v7, 3072, v7
v_lshl_add_u32 v6, v8, 4, v7
s_mul_i32 s72, s76, 160
s_mul_i32 s62, s77, 80
s_add_u32 s72, s72, s62
s_mul_i32 s72, s72, 3072
s_lshr_b32 s62, s75, 1
s_lshl_b32 s62, s62, 7
s_add_u32 s72, s72, s62
s_and_b32 s63, s75, 1
s_mul_i32 s63, s63, 3072
s_add_u32 s62, s62, s63
s_add_u32 s84, s62, 65536
v_and_b32 v7, 31, v0
v_min_u32 v7, 19, v7
s_mul_i32 s62, s61, 160
v_lshl_add_u32 v14, v7, 3, s62
buffer_load_dwordx2 v[24:25], v14, s[4:7], 0 offen
v_lshlrev_b32 v17, 1, v14
v_lshrrev_b32 v7, 5, v0
v_mul_u32_u24 v7, 2560, v7
v_add_u32 v26, v7, v17
v_min_u32 v7, 39, v0
s_mul_i32 s62, s76, 320
v_lshl_add_u32 v30, v7, 3, s62
v_lshlrev_b32 v31, 1, v30
v_lshl_add_u32 v16, v0, 3, s74
v_lshlrev_b32 v15, 4, v0
v_lshlrev_b32 v9, 2, v0
v_mov_b32 v29, 0x3acccccd
v_mov_b32 v8, 0x80000000
s_mov_b32 s63, 0
s_cbranch_execz LWD_80
LW_79:
ds_read_b32 v120, v3 offset:12
s_waitcnt lgkmcnt(0)
v_readfirstlane_b32 s62, v120
s_nop 0
s_cmp_lg_u32 s62, 0
s_cbranch_scc1 LWD_80
s_sleep 1
s_add_u32 s63, s63, 1
s_cmp_lt_u32 s63, 2400000
s_cbranch_scc1 LW_79
LWD_80:
ds_read_b64 v[120:121], v3 offset:192
v_bfe_u32 v122, v0, 2, 1
v_lshlrev_b32 v122, 5, v122
v_lshrrev_b32 v123, 3, v0
v_lshl_add_u32 v122, v123, 2, v122
v_and_b32 v123, 3, v0
v_add_u32 v122, v122, v123
v_lshlrev_b32 v122, 2, v122
s_lshl_b32 s62, s61, 8
v_add_u32 v122, s62, v122
s_waitcnt lgkmcnt(0)
v_sub_f32 v127, v127, v120
v_mul_f32 v127, 1069066811, v127
v_exp_f32 v127, v127
v_rcp_f32 v120, v121
s_nop 0
v_mul_f32 v123, v127, v120
v_fma_f32 v124, -v123, v121, v127
v_fma_f32 v125, v124, v120, v123
v_cmp_o_f32 vcc, v125, v125
s_nop 1
v_cndmask_b32 v127, v123, v125, vcc
v_cvt_pk_bf16_f32 v127, v127, v127
ds_write_b32 v122, v127 offset:2048
ds_write_b32 v5, v4 offset:128
s_mov_b32 s63, 0
s_cbranch_execz LWD_82
LW_81:
ds_read_b32 v7, v3 offset:36
s_waitcnt lgkmcnt(0)
v_readfirstlane_b32 s62, v7
s_nop 0
s_cmp_lg_u32 s62, 0
s_cbranch_scc1 LWD_82
s_sleep 1
s_add_u32 s63, s63, 1
s_cmp_lt_u32 s63, 2400000
s_cbranch_scc1 LW_81
LWD_82:
ds_read_b128 v[20:23], v17 offset:12288
ds_read_b128 v[104:107], v31 offset:14848
ds_read_b128 v[108:111], v31 offset:17408
s_mov_b32 s63, 0
s_cbranch_execz LWD_84
LW_83:
ds_read_b32 v7, v3 offset:96
s_waitcnt lgkmcnt(0)
v_readfirstlane_b32 s62, v7
s_nop 0
s_cmp_ge_u32 s62, 6
s_cbranch_scc1 LWD_84
s_sleep 1
s_add_u32 s63, s63, 1
s_cmp_lt_u32 s63, 2400000
s_cbranch_scc1 LW_83
LWD_84:
s_cbranch_execz DS_85
s_add_u32 m0, s73, 0
s_nop 0
buffer_load_dwordx4 v6, s[68:71], s72 offen nt lds
s_add_u32 s72, s72, 24576
s_add_u32 m0, s73, 1024
s_nop 0
buffer_load_dwordx4 v6, s[68:71], s72 offen nt lds
s_add_u32 s72, s72, 24576
s_add_u32 m0, s73, 2048
s_nop 0
buffer_load_dwordx4 v6, s[68:71], s72 offen nt lds
s_add_u32 s72, s72, 24576
s_waitcnt vmcnt(2)
s_add_u32 m0, s73, 3072
s_nop 0
buffer_load_dwordx4 v6, s[68:71], s72 offen nt lds
s_add_u32 s72, s72, 24576
s_waitcnt vmcnt(2)
s_add_u32 m0, s73, 4096
s_nop 0
buffer_load_dwordx4 v6, s[68:71], s72 offen nt lds
s_add_u32 s72, s72, 24576
s_waitcnt vmcnt(2)
s_add_u32 m0, s73, 5120
s_nop 0
buffer_load_dwordx4 v6, s[68:71], s72 offen nt lds
s_add_u32 s72, s72, 24576
s_waitcnt vmcnt(2)
s_add_u32 m0, s73, 6144
s_nop 0
buffer_load_dwordx4 v6, s[68:71], s72 offen nt lds
s_add_u32 s72, s72, 24576
s_waitcnt vmcnt(2)
s_add_u32 m0, s73, 7168
s_nop 0
buffer_load_dwordx4 v6, s[68:71], s72 offen nt lds
s_add_u32 s72, s72, 24576
s_waitcnt vmcnt(2)
s_add_u32 m0, s73, 8192
s_nop 0
buffer_load_dwordx4 v6, s[68:71], s72 offen nt lds
s_add_u32 s72, s72, 24576
s_waitcnt vmcnt(2)
s_add_u32 m0, s73, 9216
s_nop 0
buffer_load_dwordx4 v6, s[68:71], s72 offen nt lds
DS_85:
v_mov_b32 v112, 0
v_mov_b32 v113, 0
v_mov_b32 v114, 0
v_mov_b32 v115, 0
v_mov_b32 v116, 0
v_mov_b32 v117, 0
v_mov_b32 v118, 0
v_mov_b32 v119, 0
s_waitcnt vmcnt(0)
s_and_b32 exec_lo, s3, 1
s_mov_b32 exec_hi, 0
ds_add_u32 v3, v4 offset:40
s_mov_b32 exec_lo, s3
s_mov_b32 exec_hi, s3
s_mov_b32 s63, 0
s_cbranch_execz LWD_87
LW_86:
ds_read_b32 v7, v3 offset:40
s_waitcnt lgkmcnt(0)
v_readfirstlane_b32 s62, v7
s_nop 0
s_cmp_ge_u32 s62, 8
s_cbranch_scc1 LWD_87
s_sleep 1
s_add_u32 s63, s63, 1
s_cmp_lt_u32 s63, 2400000
s_cbranch_scc1 LW_86
LWD_87:
ds_read_b64_tr_b16 v[64:65], v10 offset:0
ds_read_b64_tr_b16 v[66:67], v10 offset:2048
ds_read_b64_tr_b16 v[68:69], v11 offset:0
ds_read_b64_tr_b16 v[70:71], v11 offset:2048
ds_read_b64_tr_b16 v[72:73], v10 offset:4096
ds_read_b64_tr_b16 v[74:75], v10 offset:6144
ds_read_b64_tr_b16 v[76:77], v11 offset:4096
ds_read_b64_tr_b16 v[78:79], v11 offset:6144
ds_read_b64_tr_b16 v[80:81], v10 offset:8192
ds_read_b64_tr_b16 v[82:83], v10 offset:10240
ds_read_b64_tr_b16 v[84:85], v11 offset:8192
ds_read_b64_tr_b16 v[86:87], v11 offset:10240
ds_read_b64_tr_b16 v[88:89], v10 offset:12288
ds_read_b64_tr_b16 v[90:91], v10 offset:14336
ds_read_b64_tr_b16 v[92:93], v11 offset:12288
ds_read_b64_tr_b16 v[94:95], v11 offset:14336
ds_read_b64_tr_b16 v[96:97], v10 offset:16384
ds_read_b64_tr_b16 v[98:99], v10 offset:18432
ds_read_b64_tr_b16 v[100:101], v11 offset:16384
ds_read_b64_tr_b16 v[102:103], v11 offset:18432
v_lshlrev_b32 v120, 16, v24
v_and_b32 v121, 0xffff0000, v24
v_lshlrev_b32 v122, 16, v25
v_and_b32 v123, 0xffff0000, v25
s_mov_b32 s80, 0
s_mov_b32 s81, 5120
s_mov_b32 s82, 10240
s_mov_b32 s83, 15360
s_mov_b32 s63, 0
s_cbranch_execz LWD_89
LW_88:
ds_read_b32 v7, v3 offset:24
s_waitcnt lgkmcnt(0)
v_readfirstlane_b32 s62, v7
s_nop 0
s_cmp_lg_u32 s62, 0
s_cbranch_scc1 LWD_89
s_sleep 1
s_add_u32 s63, s63, 1
s_cmp_lt_u32 s63, 2400000
s_cbranch_scc1 LW_88
LWD_89:
s_and_b32 exec_lo, s3, 1048575
s_and_b32 exec_hi, s3, 1048575
s_mov_b32 s85, 0xff
s_mov_b32 s63, 0
L_GP:
s_bitcmp1_b32 s85, 0
s_cbranch_scc0 L_GPI_0
s_mov_b32 s62, 0
buffer_load_dwordx4 v[32:35], v26, s[52:55], s62 offen sc1
L_GPI_0:
s_bitcmp1_b32 s85, 1
s_cbranch_scc0 L_GPI_1
s_mov_b32 s62, 5120
buffer_load_dwordx4 v[36:39], v26, s[52:55], s62 offen sc1
L_GPI_1:
s_bitcmp1_b32 s85, 2
s_cbranch_scc0 L_GPI_2
s_mov_b32 s62, 10240
buffer_load_dwordx4 v[40:43], v26, s[52:55], s62 offen sc1
L_GPI_2:
s_bitcmp1_b32 s85, 3
s_cbranch_scc0 L_GPI_3
s_mov_b32 s62, 15360
buffer_load_dwordx4 v[44:47], v26, s[52:55], s62 offen sc1
L_GPI_3:
s_bitcmp1_b32 s85, 4
s_cbranch_scc0 L_GPI_4
s_mov_b32 s62, 20480
buffer_load_dwordx4 v[48:51], v26, s[52:55], s62 offen sc1
L_GPI_4:
s_bitcmp1_b32 s85, 5
s_cbranch_scc0 L_GPI_5
s_mov_b32 s62, 25600
buffer_load_dwordx4 v[52:55], v26, s[52:55], s62 offen sc1
L_GPI_5:
s_bitcmp1_b32 s85, 6
s_cbranch_scc0 L_GPI_6
s_mov_b32 s62, 30720
buffer_load_dwordx4 v[56:59], v26, s[52:55], s62 offen sc1
L_GPI_6:
s_bitcmp1_b32 s85, 7
s_cbranch_scc0 L_GPI_7
s_mov_b32 s62, 35840
buffer_load_dwordx4 v[60:63], v26, s[52:55], s62 offen sc1
L_GPI_7:
s_waitcnt vmcnt(0)
s_bitcmp1_b32 s85, 0
s_cbranch_scc0 L_GPC_0
v_min3_u32 v7, v32, v33, v34
v_min_u32 v7, v7, v35
v_cmp_eq_u32 vcc, 0, v7
s_cbranch_vccnz L_GPC_0
s_bitset0_b32 s85, 0
L_GPC_0:
s_bitcmp1_b32 s85, 1
s_cbranch_scc0 L_GPC_1
v_min3_u32 v7, v36, v37, v38
v_min_u32 v7, v7, v39
v_cmp_eq_u32 vcc, 0, v7
s_cbranch_vccnz L_GPC_1
s_bitset0_b32 s85, 1
L_GPC_1:
s_bitcmp1_b32 s85, 2
s_cbranch_scc0 L_GPC_2
v_min3_u32 v7, v40, v41, v42
v_min_u32 v7, v7, v43
v_cmp_eq_u32 vcc, 0, v7
s_cbranch_vccnz L_GPC_2
s_bitset0_b32 s85, 2
L_GPC_2:
s_bitcmp1_b32 s85, 3
s_cbranch_scc0 L_GPC_3
v_min3_u32 v7, v44, v45, v46
v_min_u32 v7, v7, v47
v_cmp_eq_u32 vcc, 0, v7
s_cbranch_vccnz L_GPC_3
s_bitset0_b32 s85, 3
L_GPC_3:
s_bitcmp1_b32 s85, 4
s_cbranch_scc0 L_GPC_4
v_min3_u32 v7, v48, v49, v50
v_min_u32 v7, v7, v51
v_cmp_eq_u32 vcc, 0, v7
s_cbranch_vccnz L_GPC_4
s_bitset0_b32 s85, 4
L_GPC_4:
s_bitcmp1_b32 s85, 5
s_cbranch_scc0 L_GPC_5
v_min3_u32 v7, v52, v53, v54
v_min_u32 v7, v7, v55
v_cmp_eq_u32 vcc, 0, v7
s_cbranch_vccnz L_GPC_5
s_bitset0_b32 s85, 5
L_GPC_5:
s_bitcmp1_b32 s85, 6
s_cbranch_scc0 L_GPC_6
v_min3_u32 v7, v56, v57, v58
v_min_u32 v7, v7, v59
v_cmp_eq_u32 vcc, 0, v7
s_cbranch_vccnz L_GPC_6
s_bitset0_b32 s85, 6
L_GPC_6:
s_bitcmp1_b32 s85, 7
s_cbranch_scc0 L_GPC_7
v_min3_u32 v7, v60, v61, v62
v_min_u32 v7, v7, v63
v_cmp_eq_u32 vcc, 0, v7
s_cbranch_vccnz L_GPC_7
s_bitset0_b32 s85, 7
L_GPC_7:
s_cmp_eq_u32 s85, 0
s_cbranch_scc1 L_GPD
s_add_u32 s63, s63, 1
s_cmp_lt_u32 s63, 300000
s_cbranch_scc1 L_GP
L_GPD:
v_pk_add_f32 v[32:33], v[32:33], v[36:37]
v_pk_add_f32 v[34:35], v[34:35], v[38:39]
v_pk_add_f32 v[40:41], v[40:41], v[44:45]
v_pk_add_f32 v[42:43], v[42:43], v[46:47]
v_pk_add_f32 v[48:49], v[48:49], v[52:53]
v_pk_add_f32 v[50:51], v[50:51], v[54:55]
v_pk_add_f32 v[56:57], v[56:57], v[60:61]
v_pk_add_f32 v[58:59], v[58:59], v[62:63]
v_pk_add_f32 v[32:33], v[32:33], v[40:41]
v_pk_add_f32 v[34:35], v[34:35], v[42:43]
v_pk_add_f32 v[48:49], v[48:49], v[56:57]
v_pk_add_f32 v[50:51], v[50:51], v[58:59]
v_pk_add_f32 v[32:33], v[32:33], v[48:49]
v_pk_add_f32 v[34:35], v[34:35], v[50:51]
v_mov_b32 v36, v32
v_mov_b32 v37, v33
v_mov_b32 v38, v34
v_mov_b32 v39, v35
v_permlane32_swap_b32 v32, v36
v_permlane32_swap_b32 v33, v37
v_permlane32_swap_b32 v34, v38
v_permlane32_swap_b32 v35, v39
v_pk_add_f32 v[32:33], v[32:33], v[36:37]
v_pk_add_f32 v[34:35], v[34:35], v[38:39]
v_cvt_pk_bf16_f32 v33, v32, v33
v_cvt_pk_bf16_f32 v35, v34, v35
v_lshlrev_b32 v32, 16, v33
v_and_b32 v33, 0xffff0000, v33
v_lshlrev_b32 v34, 16, v35
v_and_b32 v35, 0xffff0000, v35
v_pk_mul_f32 v[32:33], v[32:33], v[20:21]
v_pk_mul_f32 v[34:35], v[34:35], v[22:23]
v_cvt_pk_bf16_f32 v33, v32, v33
v_cvt_pk_bf16_f32 v35, v34, v35
v_lshlrev_b32 v32, 16, v33
v_and_b32 v33, 0xffff0000, v33
v_lshlrev_b32 v34, 16, v35
v_and_b32 v35, 0xffff0000, v35
v_pk_add_f32 v[32:33], v[32:33], v[120:121]
v_pk_add_f32 v[34:35], v[34:35], v[122:123]
v_cvt_pk_bf16_f32 v40, v32, v33
v_cvt_pk_bf16_f32 v41, v34, v35
ds_write_b64 v14, v[40:41] offset:5120
s_mov_b32 exec_lo, s3
s_mov_b32 exec_hi, s3
s_waitcnt lgkmcnt(0)
s_cbranch_execz BR_90
s_barrier
BR_90:
ds_read_b128 v[32:35], v15 offset:5120
ds_read_b32 v36, v9 offset:6144
ds_read_b64 v[38:39], v30 offset:5120
s_cmp_lg_u32 s61, s75
s_cbranch_scc1 L_TG_NX
s_mov_b32 s62, 73728
s_and_b32 exec_lo, s3, 1048575
s_mov_b32 exec_hi, 0
v_cmp_eq_u32 vcc, 0, v40
s_nop 1
v_cndmask_b32 v40, v40, v8, vcc
v_cmp_eq_u32 vcc, 0, v41
s_nop 1
v_cndmask_b32 v41, v41, v8, vcc
buffer_store_dwordx2 v[40:41], v14, s[52:55], s62 offen sc1
s_mov_b32 exec_lo, s3
s_mov_b32 exec_hi, s3
L_TG_NX:
s_waitcnt lgkmcnt(1)
s_mov_b32 s62, 1065369472
v_dot2_f32_bf16 v48, v32, s62, 0
v_dot2_f32_bf16 v49, v32, v32, 0
v_dot2_f32_bf16 v48, v33, s62, v48
v_dot2_f32_bf16 v49, v33, v33, v49
v_dot2_f32_bf16 v48, v34, s62, v48
v_dot2_f32_bf16 v49, v34, v34, v49
v_dot2_f32_bf16 v48, v35, s62, v48
v_dot2_f32_bf16 v49, v35, v35, v49
v_dot2_f32_bf16 v48, v36, s62, v48
v_dot2_f32_bf16 v49, v36, v36, v49
s_nop 1
v_add_f32_dpp v48, v48, v48 quad_perm:[1,0,3,2] row_mask:0xf bank_mask:0xf
v_add_f32_dpp v49, v49, v49 quad_perm:[1,0,3,2] row_mask:0xf bank_mask:0xf
s_nop 0
v_add_f32_dpp v48, v48, v48 quad_perm:[2,3,0,1] row_mask:0xf bank_mask:0xf
v_add_f32_dpp v49, v49, v49 quad_perm:[2,3,0,1] row_mask:0xf bank_mask:0xf
s_nop 0
v_add_f32_dpp v48, v48, v48 row_half_mirror row_mask:0xf bank_mask:0xf
v_add_f32_dpp v49, v49, v49 row_half_mirror row_mask:0xf bank_mask:0xf
s_nop 0
v_add_f32_dpp v48, v48, v48 row_mirror row_mask:0xf bank_mask:0xf
v_add_f32_dpp v49, v49, v49 row_mirror row_mask:0xf bank_mask:0xf
s_nop 0
v_add_f32_dpp v48, v48, v48 row_bcast:15 row_mask:0xa bank_mask:0xf
v_add_f32_dpp v49, v49, v49 row_bcast:15 row_mask:0xa bank_mask:0xf
s_nop 0
v_add_f32_dpp v48, v48, v48 row_bcast:31 row_mask:0xc bank_mask:0xf
v_add_f32_dpp v49, v49, v49 row_bcast:31 row_mask:0xc bank_mask:0xf
v_readlane_b32 s62, v48, 63
v_readlane_b32 s63, v49, 63
s_nop 0
v_mul_f32 v48, s62, v29
v_mul_f32 v49, s63, v29
v_fma_f32 v49, -v48, v48, v49
v_max_f32 v49, 0, v49
v_cvt_pk_bf16_f32 v51, v48, v49
v_lshlrev_b32 v48, 16, v51
v_and_b32 v49, 0xffff0000, v51
v_add_f32 v49, 0x3727c5ac, v49
v_cvt_pk_bf16_f32 v49, v49, v49
v_and_b32 v49, 0xffff0000, v49
v_sqrt_f32 v49, v49
s_nop 0
v_cvt_pk_bf16_f32 v49, v49, v49
v_and_b32 v49, 0xffff0000, v49
v_rcp_f32 v50, v49
s_waitcnt lgkmcnt(0)
v_lshlrev_b32 v44, 16, v38
v_and_b32 v45, 0xffff0000, v38
v_lshlrev_b32 v46, 16, v39
v_and_b32 v47, 0xffff0000, v39
v_pk_add_f32 v[44:45], v[44:45], v[48:49] op_sel_hi:[1,0] neg_lo:[0,1] neg_hi:[0,1]
v_pk_add_f32 v[46:47], v[46:47], v[48:49] op_sel_hi:[1,0] neg_lo:[0,1] neg_hi:[0,1]
v_cvt_pk_bf16_f32 v45, v44, v45
v_cvt_pk_bf16_f32 v47, v46, v47
v_lshlrev_b32 v44, 16, v45
v_and_b32 v45, 0xffff0000, v45
v_lshlrev_b32 v46, 16, v47
v_and_b32 v47, 0xffff0000, v47
v_pk_mul_f32 v[44:45], v[44:45], v[50:51] op_sel_hi:[1,0]
v_pk_mul_f32 v[46:47], v[46:47], v[50:51] op_sel_hi:[1,0]
v_cvt_pk_bf16_f32 v45, v44, v45
v_cvt_pk_bf16_f32 v47, v46, v47
v_lshlrev_b32 v44, 16, v45
v_and_b32 v45, 0xffff0000, v45
v_lshlrev_b32 v46, 16, v47
v_and_b32 v47, 0xffff0000, v47
v_pk_mul_f32 v[44:45], v[44:45], v[108:109]
v_pk_mul_f32 v[46:47], v[46:47], v[110:111]
v_cvt_pk_bf16_f32 v45, v44, v45
v_cvt_pk_bf16_f32 v47, v46, v47
v_lshlrev_b32 v44, 16, v45
v_and_b32 v45, 0xffff0000, v45
v_lshlrev_b32 v46, 16, v47
v_and_b32 v47, 0xffff0000, v47
v_pk_add_f32 v[44:45], v[44:45], v[104:105]
v_pk_add_f32 v[46:47], v[46:47], v[106:107]
v_cvt_pk_bf16_f32 v36, v44, v45
v_cvt_pk_bf16_f32 v37, v46, v47
ds_write_b64 v16, v[36:37]
ds_read2_b64 v[40:43], v19 offset0:0 offset1:4
ds_read2_b64 v[44:47], v19 offset0:8 offset1:12
ds_read2_b64 v[48:51], v19 offset0:16 offset1:20
ds_read2_b64 v[52:55], v19 offset0:24 offset1:28
ds_read2_b64 v[56:59], v19 offset0:32 offset1:36
s_waitcnt lgkmcnt(4)
v_mfma_f32_16x16x32_bf16 v[112:115], v[64:67], v[40:43], v[112:115]
v_mfma_f32_16x16x32_bf16 v[116:119], v[68:71], v[40:43], v[116:119]
s_waitcnt lgkmcnt(3)
v_mfma_f32_16x16x32_bf16 v[112:115], v[72:75], v[44:47], v[112:115]
v_mfma_f32_16x16x32_bf16 v[116:119], v[76:79], v[44:47], v[116:119]
s_waitcnt lgkmcnt(2)
v_mfma_f32_16x16x32_bf16 v[112:115], v[80:83], v[48:51], v[112:115]
v_mfma_f32_16x16x32_bf16 v[116:119], v[84:87], v[48:51], v[116:119]
s_waitcnt lgkmcnt(1)
v_mfma_f32_16x16x32_bf16 v[112:115], v[88:91], v[52:55], v[112:115]
v_mfma_f32_16x16x32_bf16 v[116:119], v[92:95], v[52:55], v[116:119]
s_waitcnt lgkmcnt(0)
v_mfma_f32_16x16x32_bf16 v[112:115], v[96:99], v[56:59], v[112:115]
v_mfma_f32_16x16x32_bf16 v[116:119], v[100:103], v[56:59], v[116:119]
s_and_b32 exec_lo, s3, 65537
s_and_b32 exec_hi, s3, 65537
s_nop 4
ds_write_b128 v18, v[112:115] offset:6656
ds_write_b128 v18, v[116:119] offset:6720
s_waitcnt lgkmcnt(0)
s_cbranch_execz BR_91
s_barrier
BR_91:
s_cmp_lg_u32 s61, 0
s_cbranch_scc1 L_KEND
s_mov_b32 exec_lo, s3
s_mov_b32 exec_hi, 0
ds_read_b64 v[32:33], v27 offset:6656
ds_read_b64 v[34:35], v27 offset:6912
ds_read_b64 v[36:37], v27 offset:7168
ds_read_b64 v[38:39], v27 offset:7424
s_waitcnt lgkmcnt(0)
v_pk_add_f32 v[32:33], v[32:33], v[34:35]
v_pk_add_f32 v[36:37], v[36:37], v[38:39]
v_pk_add_f32 v[32:33], v[32:33], v[36:37]
v_cvt_pk_bf16_f32 v36, v32, v33
v_cmp_eq_u32 vcc, 0, v36
s_nop 1
v_cndmask_b32 v36, v36, v8, vcc
s_nop 1
v_mov_b32_dpp v37, v36 quad_perm:[1,1,1,1] row_mask:0xf bank_mask:0xf
v_mov_b32_dpp v38, v36 quad_perm:[2,2,2,2] row_mask:0xf bank_mask:0xf
v_mov_b32_dpp v39, v36 quad_perm:[3,3,3,3] row_mask:0xf bank_mask:0xf
s_and_b32 exec_lo, s3, 286331153
s_mov_b32 exec_hi, 0
buffer_store_dwordx4 v[36:39], v9, s[52:55], s84 offen sc1
s_branch L_KEND
L_TD:
s_mul_i32 s75, s57, 10
s_add_u32 s75, s75, s58
s_sub_u32 s75, s75, 60
v_lshrrev_b32 v7, 1, v0
v_and_b32 v8, 1, v0
v_mul_u32_u24 v7, 1280, v7
v_lshl_add_u32 v6, v8, 4, v7
s_mul_i32 s77, s61, 245760
s_lshl_b32 s62, s75, 5
s_add_u32 s77, s77, s62
s_mul_i32 s78, s61, 6144
s_add_u32 s78, s78, 77824
v_lshl_add_u32 v10, v0, 3, s78
v_and_b32 v14, 7, v0
v_lshlrev_b32 v9, 3, v14
s_mul_i32 s62, s59, 6144
v_mul_u32_u24 v11, 768, v14
v_add_u32 v11, s62, v11
s_lshl_b32 s62, s75, 5
v_lshl_add_u32 v14, v14, 2, s62
s_mul_i32 s62, s61, 384
v_lshl_add_u32 v17, v0, 3, s62
v_add_u32 v18, 8192, v14
v_lshrrev_b32 v28, 4, v0
v_lshlrev_b32 v28, 4, v28
s_lshl_b32 s62, s61, 6
v_add_u32 v28, s62, v28
s_lshl_b32 s74, s61, 9
s_add_u32 s74, s74, 8192
v_lshl_add_u32 v16, v0, 3, s74
v_lshrrev_b32 v19, 4, v0
v_lshl_add_u32 v19, v19, 3, s74
s_mov_b32 s63, 0
s_cbranch_execz LWD_93
LW_92:
ds_read_b32 v120, v3 offset:12
s_waitcnt lgkmcnt(0)
v_readfirstlane_b32 s62, v120
s_nop 0
s_cmp_lg_u32 s62, 0
s_cbranch_scc1 LWD_93
s_sleep 1
s_add_u32 s63, s63, 1
s_cmp_lt_u32 s63, 2400000
s_cbranch_scc1 LW_92
LWD_93:
ds_read_b64 v[120:121], v3 offset:192
v_bfe_u32 v122, v0, 2, 1
v_lshlrev_b32 v122, 5, v122
v_lshrrev_b32 v123, 3, v0
v_lshl_add_u32 v122, v123, 2, v122
v_and_b32 v123, 3, v0
v_add_u32 v122, v122, v123
v_lshlrev_b32 v122, 2, v122
s_lshl_b32 s62, s61, 8
v_add_u32 v122, s62, v122
s_waitcnt lgkmcnt(0)
v_sub_f32 v127, v127, v120
v_mul_f32 v127, 1069066811, v127
v_exp_f32 v127, v127
v_rcp_f32 v120, v121
s_nop 0
v_mul_f32 v123, v127, v120
v_fma_f32 v124, -v123, v121, v127
v_fma_f32 v125, v124, v120, v123
v_cmp_o_f32 vcc, v125, v125
s_nop 1
v_cndmask_b32 v127, v123, v125, vcc
v_cvt_pk_bf16_f32 v127, v127, v127
ds_write_b32 v122, v127 offset:2048
ds_write_b32 v5, v4 offset:128
s_mov_b32 s63, 0
s_cbranch_execz LWD_95
LW_94:
ds_read_b32 v7, v3 offset:36
s_waitcnt lgkmcnt(0)
v_readfirstlane_b32 s62, v7
s_nop 0
s_cmp_lg_u32 s62, 0
s_cbranch_scc1 LWD_95
s_sleep 1
s_add_u32 s63, s63, 1
s_cmp_lt_u32 s63, 2400000
s_cbranch_scc1 LW_94
LWD_95:
ds_read_b64 v[20:21], v9 offset:12288
s_mov_b32 s63, 0
s_cbranch_execz LWD_97
LW_96:
ds_read_b32 v7, v3 offset:24
s_waitcnt lgkmcnt(0)
v_readfirstlane_b32 s62, v7
s_nop 0
s_cmp_lg_u32 s62, 0
s_cbranch_scc1 LWD_97
s_sleep 1
s_add_u32 s63, s63, 1
s_cmp_lt_u32 s63, 2400000
s_cbranch_scc1 LW_96
LWD_97:
s_cbranch_execz DS_98
s_add_u32 m0, s78, 0
s_nop 0
buffer_load_dwordx4 v6, s[32:35], s77 offen nt lds
s_add_u32 s77, s77, 40960
s_add_u32 m0, s78, 1024
s_nop 0
buffer_load_dwordx4 v6, s[32:35], s77 offen nt lds
s_add_u32 s77, s77, 40960
s_add_u32 m0, s78, 2048
s_nop 0
buffer_load_dwordx4 v6, s[32:35], s77 offen nt lds
s_add_u32 s77, s77, 40960
s_waitcnt vmcnt(2)
s_add_u32 m0, s78, 3072
s_nop 0
buffer_load_dwordx4 v6, s[32:35], s77 offen nt lds
s_add_u32 s77, s77, 40960
s_waitcnt vmcnt(2)
s_add_u32 m0, s78, 4096
s_nop 0
buffer_load_dwordx4 v6, s[32:35], s77 offen nt lds
s_add_u32 s77, s77, 40960
s_waitcnt vmcnt(2)
s_add_u32 m0, s78, 5120
s_nop 0
buffer_load_dwordx4 v6, s[32:35], s77 offen nt lds
DS_98:
v_mov_b32 v24, 0
v_mov_b32 v25, 0
v_mov_b32 v26, 0
v_mov_b32 v27, 0
s_waitcnt vmcnt(0)
ds_read_b64_tr_b16 v[64:65], v10 offset:0
ds_read_b64_tr_b16 v[66:67], v10 offset:512
ds_read_b64_tr_b16 v[68:69], v10 offset:1024
ds_read_b64_tr_b16 v[70:71], v10 offset:1536
ds_read_b64_tr_b16 v[72:73], v10 offset:2048
ds_read_b64_tr_b16 v[74:75], v10 offset:2560
ds_read_b64_tr_b16 v[76:77], v10 offset:3072
ds_read_b64_tr_b16 v[78:79], v10 offset:3584
ds_read_b64_tr_b16 v[80:81], v10 offset:4096
ds_read_b64_tr_b16 v[82:83], v10 offset:4608
ds_read_b64_tr_b16 v[84:85], v10 offset:5120
ds_read_b64_tr_b16 v[86:87], v10 offset:5632
s_mov_b32 s63, 0
s_cbranch_execz LWD_100
LW_99:
ds_read_b32 v7, v3 offset:24
s_waitcnt lgkmcnt(0)
v_readfirstlane_b32 s62, v7
s_nop 0
s_cmp_lg_u32 s62, 0
s_cbranch_scc1 LWD_100
s_sleep 1
s_add_u32 s63, s63, 1
s_cmp_lt_u32 s63, 2400000
s_cbranch_scc1 LW_99
LWD_100:
s_mov_b32 s64, 65536
s_mov_b32 exec_lo, s3
s_and_b32 exec_hi, s3, 65535
s_mov_b32 s63, 0
PL_101:
buffer_load_dwordx2 v[32:33], v17, s[52:55], s64 offen sc1
buffer_load_dwordx2 v[34:35], v17, s[52:55], s64 offen offset:3072 sc1
buffer_load_dword v36, v18, s[52:55], s64 offen sc1
s_waitcnt vmcnt(0)
v_min3_u32 v7, v32, v33, v34
v_min3_u32 v7, v7, v35, v36
v_cmp_eq_u32 vcc, 0, v7
s_cbranch_vccz PD_102
s_add_u32 s63, s63, 1
s_cmp_lt_u32 s63, 300000
s_cbranch_scc1 PL_101
PD_102:
v_lshlrev_b32 v40, 16, v32
v_and_b32 v41, 0xffff0000, v32
v_lshlrev_b32 v42, 16, v33
v_and_b32 v43, 0xffff0000, v33
v_lshlrev_b32 v44, 16, v34
v_and_b32 v45, 0xffff0000, v34
v_lshlrev_b32 v46, 16, v35
v_and_b32 v47, 0xffff0000, v35
v_pk_mul_f32 v[40:41], v[40:41], v[44:45]
v_pk_mul_f32 v[42:43], v[42:43], v[46:47]
v_cvt_pk_bf16_f32 v32, v40, v41
v_cvt_pk_bf16_f32 v33, v42, v43
ds_write_b64 v16, v[32:33]
s_mov_b32 exec_lo, s3
s_mov_b32 exec_hi, s3
ds_read2_b64 v[40:43], v19 offset0:0 offset1:4
ds_read2_b64 v[44:47], v19 offset0:8 offset1:12
ds_read2_b64 v[48:51], v19 offset0:16 offset1:20
ds_read2_b64 v[52:55], v19 offset0:24 offset1:28
ds_read2_b64 v[56:59], v19 offset0:32 offset1:36
ds_read2_b64 v[60:63], v19 offset0:40 offset1:44
v_lshlrev_b32 v38, 16, v36
v_and_b32 v39, 0xffff0000, v36
s_waitcnt lgkmcnt(5)
v_mfma_f32_16x16x32_bf16 v[24:27], v[64:67], v[40:43], v[24:27]
s_waitcnt lgkmcnt(4)
v_mfma_f32_16x16x32_bf16 v[24:27], v[68:71], v[44:47], v[24:27]
s_waitcnt lgkmcnt(3)
v_mfma_f32_16x16x32_bf16 v[24:27], v[72:75], v[48:51], v[24:27]
s_waitcnt lgkmcnt(2)
v_mfma_f32_16x16x32_bf16 v[24:27], v[76:79], v[52:55], v[24:27]
s_waitcnt lgkmcnt(1)
v_mfma_f32_16x16x32_bf16 v[24:27], v[80:83], v[56:59], v[24:27]
s_waitcnt lgkmcnt(0)
v_mfma_f32_16x16x32_bf16 v[24:27], v[84:87], v[60:63], v[24:27]
s_and_b32 exec_lo, s3, 65537
s_and_b32 exec_hi, s3, 65537
s_nop 5
ds_write_b128 v28, v[24:27] offset:6656
s_waitcnt lgkmcnt(0)
s_cbranch_execz BR_103
s_barrier
BR_103:
s_cmp_lg_u32 s61, 0
s_cbranch_scc1 L_KEND
s_and_b32 exec_lo, s3, 255
s_mov_b32 exec_hi, 0
ds_read_b64 v[64:65], v9 offset:6656
ds_read_b64 v[66:67], v9 offset:6720
ds_read_b64 v[68:69], v9 offset:6784
ds_read_b64 v[70:71], v9 offset:6848
ds_read_b64 v[72:73], v9 offset:6912
ds_read_b64 v[74:75], v9 offset:6976
ds_read_b64 v[76:77], v9 offset:7040
ds_read_b64 v[78:79], v9 offset:7104
s_waitcnt lgkmcnt(0)
v_pk_add_f32 v[64:65], v[64:65], v[66:67]
v_pk_add_f32 v[68:69], v[68:69], v[70:71]
v_pk_add_f32 v[72:73], v[72:73], v[74:75]
v_pk_add_f32 v[76:77], v[76:77], v[78:79]
v_pk_add_f32 v[64:65], v[64:65], v[68:69]
v_pk_add_f32 v[72:73], v[72:73], v[76:77]
v_pk_add_f32 v[64:65], v[64:65], v[72:73]
v_cvt_pk_bf16_f32 v68, v64, v65
v_lshlrev_b32 v64, 16, v68
v_and_b32 v65, 0xffff0000, v68
v_pk_mul_f32 v[64:65], v[64:65], v[20:21]
v_cvt_pk_bf16_f32 v68, v64, v65
v_lshlrev_b32 v64, 16, v68
v_and_b32 v65, 0xffff0000, v68
v_pk_add_f32 v[64:65], v[64:65], v[38:39]
v_cvt_pk_bf16_f32 v68, v64, v65
buffer_store_dword v68, v14, s[44:47], 0 offen
L_KEND:
s_cbranch_execz L_DRYRET
L_END:
s_endpgm
.section .rodata,"a"
.p2align 6
.amdhsa_kernel adaLN_cond__gqa_block_cached__glu_gated_bilinear__decode_kernel
.amdhsa_next_free_vgpr 128
.amdhsa_next_free_sgpr 102
.amdhsa_accum_offset 128
.amdhsa_group_segment_fixed_size 0
.amdhsa_kernarg_size 112
.amdhsa_user_sgpr_count 2
.amdhsa_user_sgpr_kernarg_segment_ptr 1
.amdhsa_system_sgpr_workgroup_id_x 1
.amdhsa_float_denorm_mode_32 3
.amdhsa_float_denorm_mode_16_64 3
.end_amdhsa_kernel
```
